```python
import torch

def _softmax(x, axis=-1):
    return torch.softmax(x, dim=axis)
def _gelu(x):
    return torch.nn.functional.gelu(x, approximate="tanh")
def _silu(x):
    return torch.nn.functional.silu(x)
def _sigmoid(x):
    return torch.sigmoid(x)
def _layernorm(x, axis=-1, eps=1e-5):
    m = x.mean(dim=axis, keepdim=True)
    v = x.var(dim=axis, keepdim=True, unbiased=False)
    return (x - m) / torch.sqrt(v + eps)
def _scatter_add(tgt, idx, src, axis=0):
    return tgt.clone().index_add_(axis, idx, src)
def _segment_sum(src, seg, n):
    out = torch.zeros((n,) + src.shape[1:], dtype=src.dtype)
    return out.index_add_(0, seg, src)
def _pad(x, pw):
    flat = tuple(v for pair in reversed(pw) for v in pair)
    return torch.nn.functional.pad(x, flat)

kernel_name = 'recurrent_scan__compressed_kv_cla__dense_activation_squared_relu__decode'

def setup_inputs():

    _w = (lambda a: (lambda t: t.to(torch.bfloat16) if t.is_floating_point() else t)(torch.as_tensor(a)))
    def _A_setup():
        B, H, Sq, Sk, D, M = 1, 32, 1, 4096, 128, 640
        Dc = 4 * D
        return {
            "x": _w((lambda *s: torch.randn(*s, dtype=torch.bfloat16) * 0.05)(B, Sq, M)),
            "c_kv": _w((lambda *s: torch.randn(*s, dtype=torch.bfloat16) * 0.2)(B, Sk, Dc)),
            "w_q": _w((lambda *s: torch.randn(*s, dtype=torch.bfloat16) * 3.2)(M, H, D) * (M ** -0.5)),
            "w_uk": _w((lambda *s: torch.randn(*s, dtype=torch.bfloat16) * 3.2)(Dc, H, D) * (Dc ** -0.5)),
            "w_uv": _w((lambda *s: torch.randn(*s, dtype=torch.bfloat16) * 0.2)(Dc, H, D) * (Dc ** -0.5)),
            "w_o": _w((lambda *s: torch.randn(*s, dtype=torch.bfloat16) * 0.2)(H, D, M) * ((H * D) ** -0.5)),
        }
    _A_in = _A_setup()

    def _B_setup():
        B, S, D, F = 1, 1, 640, 1728
        return {
            "x": _w((lambda *s: torch.randn(*s, dtype=torch.bfloat16) * 0.05)(B, S, D)),
            "w1": _w((lambda *s: torch.randn(*s, dtype=torch.bfloat16) * 0.1)(D, F)),
            "b1": _w((lambda *s: torch.randn(*s, dtype=torch.bfloat16) * 0.8)(F)),
            "w2": _w((lambda *s: torch.randn(*s, dtype=torch.bfloat16) * 0.1)(F, D)),
            "b2": _w((lambda *s: torch.randn(*s, dtype=torch.bfloat16) * 12.8)(D)),
        }
    _B_in = _B_setup()

    return {
        "A_x": _A_in["x"],
        "A_c_kv": _A_in["c_kv"],
        "A_w_q": _A_in["w_q"],
        "A_w_uk": _A_in["w_uk"],
        "A_w_uv": _A_in["w_uv"],
        "A_w_o": _A_in["w_o"],
        "B_x": _B_in["x"],
        "B_w1": _B_in["w1"],
        "B_b1": _B_in["b1"],
        "B_w2": _B_in["w2"],
        "B_b2": _B_in["b2"],
    }

def reference(A_x, A_c_kv, A_w_q, A_w_uk, A_w_uv, A_w_o, B_x, B_w1, B_b1, B_w2, B_b2):
    def _A_ref(x, c_kv, w_q, w_uk, w_uv, w_o):
        B, Sq, M = x.shape[0], x.shape[1], x.shape[2]
        Sk = c_kv.shape[1]
        H, D = w_q.shape[1], w_q.shape[2]
        q = torch.einsum("bqm,mhd->bhqd", x, w_q)
        k = torch.einsum("bkc,chd->bhkd", c_kv, w_uk)
        v = torch.einsum("bkc,chd->bhkd", c_kv, w_uv)
        scores = torch.einsum("bhqd,bhkd->bhqk", q, k) * (D ** -0.5)
        off = Sk - Sq
        qi = torch.arange(Sq)[:, None]
        kj = torch.arange(Sk)[None, :]
        cmask = kj <= (qi + off)
        scores = torch.where(cmask[None, None], scores, -1e9)
        p = _softmax(scores, axis=-1)
        ctx = torch.einsum("bhqk,bhkd->bhqd", p, v)
        return torch.einsum("bhqd,hdm->bqm", ctx, w_o)

    def _B_ref(x, w1, b1, w2, b2):
        h = torch.einsum("bsd,df->bsf", x, w1) + b1
        zero = torch.zeros_like(h)
        r = torch.where(h > zero, h, zero)
        h = r * r
        out = torch.einsum("bsf,fd->bsd", h, w2) + b2
        return out

    x = A_x
    xn = _layernorm(x, axis=-1)
    s = _A_ref(xn, A_c_kv, A_w_q, A_w_uk, A_w_uv, A_w_o)
    g = _silu(_B_ref(xn, B_w1, B_b1, B_w2, B_b2))
    return x + s * g
```

```asm
; @launch grid=(256,1,1) block=(256,1,1) lds=163840
.amdgcn_target "amdgcn-amd-amdhsa--gfx950"
.text
.p2align 12
.fill 832, 4, 0xbf810000
.globl recurrent_scan__compressed_kv_cla__dense_activation_squared_relu__decode_kernel
.p2align 8
.type recurrent_scan__compressed_kv_cla__dense_activation_squared_relu__decode_kernel,@function
recurrent_scan__compressed_kv_cla__dense_activation_squared_relu__decode_kernel:
    s_load_dwordx16 s[40:55], s[0:1], 0
    s_load_dwordx2 s[4:5], s[0:1], 104
    s_load_dwordx8 s[56:63], s[0:1], 64
    s_lshr_b32 s36, s2, 3
    s_cmp_ge_u32 s36, 32
    s_cbranch_scc1 L_end
    s_getpc_b64 s[32:33]
L_pc:
    s_lshl_b32 s93, s36, 10
    v_lshrrev_b32 v1, 5, v0
    v_lshl_add_u32 v1, v1, 7, s93
    v_min_u32 v1, L_codeend-L_pc-4, v1
    global_load_dword v250, v1, s[32:33]
    v_lshrrev_b32 v1, 6, v0
    v_lshrrev_b32 v4, 3, v0
    v_and_b32 v3, 7, v0
    v_and_b32 v0, 63, v0
    s_and_b32 s35, s2, 7
    v_readfirstlane_b32 s3, v1
    s_mov_b32 s6, -1
    s_mov_b32 s7, 0x20000
    s_mov_b64 s[10:11], s[6:7]
    s_mov_b64 s[14:15], s[6:7]
    s_mov_b64 s[18:19], s[6:7]
    v_lshrrev_b32 v2, 3, v0
    v_min_u32 v6, 9, v0
    v_lshlrev_b32 v6, 7, v6
    s_mul_i32 s94, s36, 6
    s_sub_u32 s94, s94, 48
    s_mul_i32 s95, s36, 7
    s_add_u32 s95, s95, -64
    s_cmp_ge_u32 s36, 16
    s_cselect_b32 s94, s95, s94
    s_cselect_b32 s95, 6, 5
    v_mul_u32_u24 v5, 160, v1
    v_min_u32 v7, s95, v2
    v_add3_u32 v5, v5, s94, v7
    v_min_u32 v5, 0x27f, v5
    v_lshrrev_b32 v7, 5, v5
    v_and_b32 v5, 31, v5
    v_mad_u32_u24 v5, v5, 20, v7
    v_lshlrev_b32 v5, 13, v5
    v_lshl_or_b32 v5, v3, 7, v5
    s_lshl_b32 s93, s35, 10
    s_cmp_lt_u32 s36, 8
    s_waitcnt lgkmcnt(0)
    s_mov_b64 s[8:9], s[40:41]
    s_mov_b64 s[12:13], s[44:45]
    s_mov_b64 s[16:17], s[46:47]
    s_load_dword s34, s[4:5], 0
    buffer_load_dword v250, v6, s[8:11], 0 offen
    s_cbranch_scc1 LA_start
    buffer_load_dword v250, v5, s[12:15], s93 offen
    s_mul_i32 s94, s36, 6
    s_sub_u32 s94, s94, 48
    s_mul_i32 s95, s36, 5
    s_add_u32 s95, s95, -32
    s_cmp_ge_u32 s36, 16
    s_cselect_b32 s94, s95, s94
    s_cselect_b32 s95, 4, 5
    v_lshlrev_b32 v5, 7, v1
    v_min_u32 v7, s95, v2
    v_add3_u32 v5, v5, s94, v7
    v_min_u32 v5, 0x1ff, v5
    v_lshrrev_b32 v7, 5, v5
    v_and_b32 v5, 31, v5
    v_lshl_add_u32 v5, v5, 4, v7
    v_lshlrev_b32 v5, 13, v5
    v_lshl_or_b32 v5, v3, 7, v5
    buffer_load_dword v250, v5, s[16:19], s93 offen
    s_cmp_ge_u32 s36, 16
    s_cbranch_scc1 LY_start
    s_branch LP_start
LA_start:
    s_mov_b64 s[20:21], s[54:55]
    s_mov_b64 s[24:25], s[58:59]
    s_mov_b64 s[28:29], s[56:57]
    s_mov_b64 s[52:53], s[50:51]
    s_lshl_b32 s37, s35, 3
    s_add_u32 s37, s37, s36
    s_lshl_b32 s38, s37, 7
    v_lshlrev_b32 v14, 4, v3
    v_mul_u32_u24 v1, 163840, v4
    v_add_u32 v1, v1, v14
    v_lshl_or_b32 v15, v4, 17, v14
    v_mul_u32_u24 v9, 40, v4
    v_mul_u32_u24 v106, 20, v0
    s_mov_b32 s40, s38
    s_mov_b32 s43, s38
    s_movk_i32 s44, 0x2000
    buffer_load_dwordx4 v[96:99], v9, s[8:11], 0 offen
    buffer_load_dwordx4 v[100:103], v9, s[8:11], 0 offen offset:16
    buffer_load_dwordx2 v[104:105], v9, s[8:11], 0 offen offset:32
    buffer_load_dwordx4 a[0:3], v1, s[12:15], s40 offen
    s_add_u32 s40, s40, s44
    buffer_load_dwordx4 v[4:7], v106, s[8:11], 0 offen
    buffer_load_dword v8, v106, s[8:11], 0 offen offset:16
    buffer_load_dwordx4 a[4:7], v1, s[12:15], s40 offen
    s_add_u32 s40, s40, s44
    buffer_load_dwordx4 a[8:11], v1, s[12:15], s40 offen
    s_add_u32 s40, s40, s44
    buffer_load_dwordx4 a[12:15], v1, s[12:15], s40 offen
    s_add_u32 s40, s40, s44
    buffer_load_dwordx4 a[16:19], v1, s[12:15], s40 offen
    s_add_u32 s40, s40, s44
    buffer_load_dwordx4 a[20:23], v1, s[12:15], s40 offen
    s_add_u32 s40, s40, s44
    buffer_load_dwordx4 a[24:27], v1, s[12:15], s40 offen
    s_add_u32 s40, s40, s44
    buffer_load_dwordx4 a[28:31], v1, s[12:15], s40 offen
    s_add_u32 s40, s40, s44
    v_min_u32 v106, 1, v0
    v_mul_u32_u24 v106, 0x290000, v106
    buffer_load_dword v250, v106, s[4:7], 0 offen offset:2048
    s_mov_b64 exec, 0
    s_cmp_eq_u32 s3, 3
    s_cbranch_scc1 A_pg1
    s_cmp_eq_u32 s3, 2
    s_cbranch_scc1 LA_back
LA_back:
    s_mov_b64 exec, -1
    s_and_b32 s39, s36, 1
    v_and_b32 v106, 1, v0
    v_cmp_eq_u32 vcc, 1, v106
    v_mov_b32 v107, 0x0c0c0100
    v_mov_b32 v124, 0x01000c0c
    v_cndmask_b32 v107, v107, v124, vcc
    v_mov_b32 v124, 0x0c0c0302
    v_mov_b32 v125, 0x03020c0c
    v_cndmask_b32 v124, v124, v125, vcc
    v_mov_b32 v125, 0x0c0c0c0c
    v_lshrrev_b32 v106, 1, v3
    s_mov_b32 s45, 0x3f803f80
    v_cmp_eq_u32 vcc, 0, v106
    s_nop 1
    v_cndmask_b32 v108, v125, v107, vcc
    v_cndmask_b32 v112, v125, v124, vcc
    v_cmp_eq_u32 vcc, 1, v106
    s_nop 1
    v_cndmask_b32 v109, v125, v107, vcc
    v_cndmask_b32 v113, v125, v124, vcc
    v_cmp_eq_u32 vcc, 2, v106
    s_nop 1
    v_cndmask_b32 v110, v125, v107, vcc
    v_cndmask_b32 v114, v125, v124, vcc
    v_cmp_eq_u32 vcc, 3, v106
    s_nop 1
    v_cndmask_b32 v111, v125, v107, vcc
    v_cndmask_b32 v115, v125, v124, vcc
    v_lshrrev_b32 v106, 4, v0
    v_and_b32 v106, 1, v106
    v_lshlrev_b32 v106, 5, v106
    v_add_u32 v106, v106, v3
    v_lshlrev_b32 v106, 5, v106
    v_lshrrev_b32 v107, 5, v0
    v_lshl_add_u32 v106, v107, 2, v106
    s_lshl_b32 s45, s3, 3
    s_add_u32 s45, s45, 4096
    v_add_u32 v126, s45, v106
    v_lshlrev_b32 v127, 5, v0
    v_add_u32 v127, 4096, v127
    v_lshlrev_b32 v211, 4, v0
    v_and_b32 v106, 3, v0
    v_lshlrev_b32 v106, 1, v106
    v_bfe_u32 v107, v0, 2, 1
    v_lshl_or_b32 v125, v2, 3, v106
    v_or_b32 v125, v125, v107
    v_lshrrev_b32 v106, 4, v125
    v_bfe_u32 v107, v125, 2, 2
    v_lshlrev_b32 v107, 4, v107
    v_lshl_add_u32 v124, v106, 2, v107
    v_add_u32 v124, 256, v124
    v_add_u32 v107, 328, v107
    v_cmp_eq_u32 vcc, 3, v106
    s_nop 1
    v_cndmask_b32 v124, v124, v107, vcc
    v_lshlrev_b32 v107, 2, v125
    v_and_b32 v106, 3, v125
    v_cmp_eq_u32 vcc, 3, v106
    s_nop 1
    v_cndmask_b32 v210, v107, v124, vcc
    s_lshl_b32 s45, s3, 9
    s_add_u32 s45, s45, 6144
    v_add_u32 v210, s45, v210
    v_add_u32 v216, s45, v211
    s_mov_b32 s56, 286331153
    s_mov_b32 s57, s56
    s_waitcnt lgkmcnt(0)
    s_mul_i32 s34, s34, 0x9E3779B1
    s_add_u32 s34, s34, 0x7F4A7C15
    v_mov_b32 v212, s34
    v_mov_b32 v213, s34
    v_mov_b32 v214, s34
    v_mov_b32 v215, s34
    s_lshl_b32 s46, s37, 2
    s_add_u32 s46, s46, s3
    s_lshl_b32 s46, s46, 10
    s_add_u32 s46, s46, 2752512
    s_mul_i32 s47, s37, 1536
    s_mul_i32 s45, s3, 384
    s_add_u32 s47, s47, s45
    s_add_u32 s47, s47, 65536
    s_mov_b32 s22, 2211840
    s_mov_b32 s23, s7
    s_mov_b32 s26, 2211840
    s_mov_b32 s27, s7
    s_mov_b32 s30, 3456
    s_mov_b32 s31, s7
    s_mov_b32 s50, 4194304
    s_mov_b32 s51, s7
    s_mov_b32 s54, 5242880
    s_mov_b32 s55, s7
    s_waitcnt vmcnt(8)
    v_lshlrev_b32 v222, 16, v4
    v_and_b32 v223, 0xffff0000, v4
    v_lshlrev_b32 v224, 16, v5
    v_and_b32 v225, 0xffff0000, v5
    v_lshlrev_b32 v226, 16, v6
    v_and_b32 v227, 0xffff0000, v6
    v_lshlrev_b32 v228, 16, v7
    v_and_b32 v229, 0xffff0000, v7
    v_lshlrev_b32 v230, 16, v8
    v_and_b32 v231, 0xffff0000, v8
    v_add_f32 v220, v222, v223
    v_add_f32 v221, v224, v225
    v_add_f32 v220, v220, v226
    v_add_f32 v221, v221, v227
    v_add_f32 v220, v220, v228
    v_add_f32 v221, v221, v229
    v_add_f32 v220, v220, v230
    v_add_f32 v221, v221, v231
    v_add_f32 v220, v220, v221
    s_nop 1
    v_add_f32_dpp v220, v220, v220 quad_perm:[1,0,3,2] row_mask:0xf bank_mask:0xf
    s_nop 1
    v_add_f32_dpp v220, v220, v220 quad_perm:[2,3,0,1] row_mask:0xf bank_mask:0xf
    s_nop 1
    v_add_f32_dpp v220, v220, v220 row_half_mirror row_mask:0xf bank_mask:0xf
    s_nop 1
    v_add_f32_dpp v220, v220, v220 row_mirror row_mask:0xf bank_mask:0xf
    v_mov_b32 v221, v220
    s_nop 1
    v_permlane16_swap_b32 v220, v221
    buffer_load_dwordx4 a[32:35], v1, s[12:15], s40 offen
    s_add_u32 s40, s40, s44
    v_add_f32 v220, v220, v221
    v_mov_b32 v221, v220
    s_nop 1
    v_permlane32_swap_b32 v220, v221
    v_add_f32 v220, v220, v221
    v_mul_f32 v220, 0x3acccccd, v220
    v_sub_f32 v222, v222, v220
    v_sub_f32 v223, v223, v220
    v_sub_f32 v224, v224, v220
    v_sub_f32 v225, v225, v220
    v_sub_f32 v226, v226, v220
    v_sub_f32 v227, v227, v220
    v_sub_f32 v228, v228, v220
    v_sub_f32 v229, v229, v220
    v_sub_f32 v230, v230, v220
    v_sub_f32 v231, v231, v220
    v_mul_f32 v221, v222, v222
    v_mul_f32 v232, v223, v223
    v_fmac_f32 v221, v224, v224
    v_fmac_f32 v232, v225, v225
    v_fmac_f32 v221, v226, v226
    v_fmac_f32 v232, v227, v227
    v_fmac_f32 v221, v228, v228
    v_fmac_f32 v232, v229, v229
    v_fmac_f32 v221, v230, v230
    buffer_load_dwordx4 a[36:39], v1, s[12:15], s40 offen
    s_add_u32 s40, s40, s44
    v_fmac_f32 v232, v231, v231
    v_add_f32 v221, v221, v232
    s_nop 1
    v_add_f32_dpp v221, v221, v221 quad_perm:[1,0,3,2] row_mask:0xf bank_mask:0xf
    s_nop 1
    v_add_f32_dpp v221, v221, v221 quad_perm:[2,3,0,1] row_mask:0xf bank_mask:0xf
    s_nop 1
    v_add_f32_dpp v221, v221, v221 row_half_mirror row_mask:0xf bank_mask:0xf
    s_nop 1
    v_add_f32_dpp v221, v221, v221 row_mirror row_mask:0xf bank_mask:0xf
    v_mov_b32 v232, v221
    s_nop 1
    v_permlane16_swap_b32 v221, v232
    v_add_f32 v221, v221, v232
    v_mov_b32 v232, v221
    s_nop 1
    v_permlane32_swap_b32 v221, v232
    v_add_f32 v221, v221, v232
    v_mul_f32 v221, 0x3acccccd, v221
    v_cvt_pk_bf16_f32 v220, v220, v221
    v_and_b32 v221, 0xffff0000, v220
    v_lshlrev_b32 v220, 16, v220
    v_add_f32 v221, 0x3727c5ac, v221
    v_cvt_pk_bf16_f32 v221, v221, v221
    v_lshlrev_b32 v221, 16, v221
    v_sqrt_f32 v221, v221
    s_nop 0
    v_cvt_pk_bf16_f32 v221, v221, v221
    v_lshlrev_b32 v221, 16, v221
    v_rcp_f32 v221, v221
    v_lshlrev_b32 v10, 16, v96
    v_and_b32 v11, 0xffff0000, v96
    v_sub_f32 v10, v10, v220
    v_sub_f32 v11, v11, v220
    v_cvt_pk_bf16_f32 v96, v10, v11
    v_lshlrev_b32 v10, 16, v96
    v_and_b32 v11, 0xffff0000, v96
    v_mul_f32 v10, v10, v221
    v_mul_f32 v11, v11, v221
    v_cvt_pk_bf16_f32 v96, v10, v11
    v_perm_b32 v16, v96, v96, v108
    v_perm_b32 v17, v96, v96, v109
    v_perm_b32 v18, v96, v96, v110
    v_perm_b32 v19, v96, v96, v111
    v_perm_b32 v20, v96, v96, v112
    v_perm_b32 v21, v96, v96, v113
    v_perm_b32 v22, v96, v96, v114
    v_perm_b32 v23, v96, v96, v115
    s_waitcnt vmcnt(12)
    v_mfma_f32_16x16x32_bf16 v[120:123], v[16:19], a[0:3], 0
    buffer_load_dwordx4 a[40:43], v1, s[12:15], s40 offen
    s_add_u32 s40, s40, s44
    v_lshlrev_b32 v10, 16, v97
    v_and_b32 v11, 0xffff0000, v97
    v_sub_f32 v10, v10, v220
    v_sub_f32 v11, v11, v220
    v_cvt_pk_bf16_f32 v97, v10, v11
    v_lshlrev_b32 v10, 16, v97
    v_and_b32 v11, 0xffff0000, v97
    v_mul_f32 v10, v10, v221
    v_mul_f32 v11, v11, v221
    v_cvt_pk_bf16_f32 v97, v10, v11
    v_perm_b32 v24, v97, v97, v108
    v_perm_b32 v25, v97, v97, v109
    v_perm_b32 v26, v97, v97, v110
    v_perm_b32 v27, v97, v97, v111
    s_waitcnt vmcnt(10)
    v_mfma_f32_16x16x32_bf16 v[120:123], v[20:23], a[4:7], v[120:123]
    buffer_load_dwordx4 a[44:47], v1, s[12:15], s40 offen
    s_add_u32 s40, s40, s44
    v_perm_b32 v28, v97, v97, v112
    v_perm_b32 v29, v97, v97, v113
    v_perm_b32 v30, v97, v97, v114
    v_perm_b32 v31, v97, v97, v115
    s_waitcnt vmcnt(10)
    v_mfma_f32_16x16x32_bf16 v[120:123], v[24:27], a[8:11], v[120:123]
    buffer_load_dwordx4 a[48:51], v1, s[12:15], s40 offen
    s_add_u32 s40, s40, s44
    v_lshlrev_b32 v10, 16, v98
    v_and_b32 v11, 0xffff0000, v98
    v_sub_f32 v10, v10, v220
    v_sub_f32 v11, v11, v220
    v_cvt_pk_bf16_f32 v98, v10, v11
    v_lshlrev_b32 v10, 16, v98
    v_and_b32 v11, 0xffff0000, v98
    v_mul_f32 v10, v10, v221
    v_mul_f32 v11, v11, v221
    v_cvt_pk_bf16_f32 v98, v10, v11
    v_perm_b32 v32, v98, v98, v108
    v_perm_b32 v33, v98, v98, v109
    v_perm_b32 v34, v98, v98, v110
    v_perm_b32 v35, v98, v98, v111
    s_waitcnt vmcnt(10)
    v_mfma_f32_16x16x32_bf16 v[120:123], v[28:31], a[12:15], v[120:123]
    buffer_load_dwordx4 a[52:55], v1, s[12:15], s40 offen
    s_add_u32 s40, s40, s44
    v_perm_b32 v36, v98, v98, v112
    v_perm_b32 v37, v98, v98, v113
    v_perm_b32 v38, v98, v98, v114
    v_perm_b32 v39, v98, v98, v115
    s_waitcnt vmcnt(10)
    v_mfma_f32_16x16x32_bf16 v[120:123], v[32:35], a[16:19], v[120:123]
    buffer_load_dwordx4 a[56:59], v1, s[12:15], s40 offen
    s_add_u32 s40, s40, s44
    v_lshlrev_b32 v10, 16, v99
    v_and_b32 v11, 0xffff0000, v99
    v_sub_f32 v10, v10, v220
    v_sub_f32 v11, v11, v220
    v_cvt_pk_bf16_f32 v99, v10, v11
    v_lshlrev_b32 v10, 16, v99
    v_and_b32 v11, 0xffff0000, v99
    v_mul_f32 v10, v10, v221
    v_mul_f32 v11, v11, v221
    v_cvt_pk_bf16_f32 v99, v10, v11
    v_perm_b32 v40, v99, v99, v108
    v_perm_b32 v41, v99, v99, v109
    v_perm_b32 v42, v99, v99, v110
    v_perm_b32 v43, v99, v99, v111
    v_mov_b32 v222, 0
    v_mov_b32 v223, 0
    s_waitcnt vmcnt(10)
    v_mfma_f32_16x16x32_bf16 v[120:123], v[36:39], a[20:23], v[120:123]
    buffer_load_dwordx4 a[60:63], v1, s[12:15], s40 offen
    s_add_u32 s40, s40, s44
    v_perm_b32 v44, v99, v99, v112
    v_perm_b32 v45, v99, v99, v113
    v_perm_b32 v46, v99, v99, v114
    v_perm_b32 v47, v99, v99, v115
    v_mov_b32 v224, 0
    v_mov_b32 v225, 0
    s_waitcnt vmcnt(10)
    v_mfma_f32_16x16x32_bf16 v[120:123], v[40:43], a[24:27], v[120:123]
    buffer_load_dwordx4 a[64:67], v1, s[12:15], s40 offen
    s_add_u32 s40, s40, s44
    v_lshlrev_b32 v10, 16, v100
    v_and_b32 v11, 0xffff0000, v100
    v_sub_f32 v10, v10, v220
    v_sub_f32 v11, v11, v220
    v_cvt_pk_bf16_f32 v100, v10, v11
    v_lshlrev_b32 v10, 16, v100
    v_and_b32 v11, 0xffff0000, v100
    v_mul_f32 v10, v10, v221
    v_mul_f32 v11, v11, v221
    v_cvt_pk_bf16_f32 v100, v10, v11
    v_perm_b32 v48, v100, v100, v108
    v_perm_b32 v49, v100, v100, v109
    v_perm_b32 v50, v100, v100, v110
    v_perm_b32 v51, v100, v100, v111
    v_mov_b32 v226, 0
    v_mov_b32 v227, 0
    s_waitcnt vmcnt(10)
    v_mfma_f32_16x16x32_bf16 v[120:123], v[44:47], a[28:31], v[120:123]
    buffer_load_dwordx4 a[68:71], v1, s[12:15], s40 offen
    s_add_u32 s40, s40, s44
    v_perm_b32 v52, v100, v100, v112
    v_perm_b32 v53, v100, v100, v113
    v_perm_b32 v54, v100, v100, v114
    v_perm_b32 v55, v100, v100, v115
    v_mov_b32 v228, 0
    v_mov_b32 v229, 0
    s_waitcnt vmcnt(9)
    v_mfma_f32_16x16x32_bf16 v[120:123], v[48:51], a[32:35], v[120:123]
    buffer_load_dwordx4 a[72:75], v1, s[12:15], s40 offen
    s_add_u32 s40, s40, s44
    v_lshlrev_b32 v10, 16, v101
    v_and_b32 v11, 0xffff0000, v101
    v_sub_f32 v10, v10, v220
    v_sub_f32 v11, v11, v220
    v_cvt_pk_bf16_f32 v101, v10, v11
    v_lshlrev_b32 v10, 16, v101
    v_and_b32 v11, 0xffff0000, v101
    v_mul_f32 v10, v10, v221
    v_mul_f32 v11, v11, v221
    v_cvt_pk_bf16_f32 v101, v10, v11
    v_perm_b32 v56, v101, v101, v108
    v_perm_b32 v57, v101, v101, v109
    v_perm_b32 v58, v101, v101, v110
    v_perm_b32 v59, v101, v101, v111
    v_mov_b32 v230, 0
    v_mov_b32 v231, 0
    s_waitcnt vmcnt(9)
    v_mfma_f32_16x16x32_bf16 v[120:123], v[52:55], a[36:39], v[120:123]
    buffer_load_dwordx4 a[76:79], v1, s[12:15], s40 offen
    s_add_u32 s40, s40, s44
    v_perm_b32 v60, v101, v101, v112
    v_perm_b32 v61, v101, v101, v113
    v_perm_b32 v62, v101, v101, v114
    v_perm_b32 v63, v101, v101, v115
    v_mov_b32 v232, 0
    v_mov_b32 v233, 0
    s_waitcnt vmcnt(9)
    v_mfma_f32_16x16x32_bf16 v[120:123], v[56:59], a[40:43], v[120:123]
    buffer_load_dwordx4 v[128:131], v15, s[16:19], s43 offen
    s_add_u32 s43, s43, s44
    v_lshlrev_b32 v10, 16, v102
    v_and_b32 v11, 0xffff0000, v102
    v_sub_f32 v10, v10, v220
    v_sub_f32 v11, v11, v220
    v_cvt_pk_bf16_f32 v102, v10, v11
    v_lshlrev_b32 v10, 16, v102
    v_and_b32 v11, 0xffff0000, v102
    v_mul_f32 v10, v10, v221
    v_mul_f32 v11, v11, v221
    v_cvt_pk_bf16_f32 v102, v10, v11
    v_perm_b32 v64, v102, v102, v108
    v_perm_b32 v65, v102, v102, v109
    v_perm_b32 v66, v102, v102, v110
    v_perm_b32 v67, v102, v102, v111
    v_mov_b32 v234, 0
    v_mov_b32 v235, 0
    s_waitcnt vmcnt(9)
    v_mfma_f32_16x16x32_bf16 v[120:123], v[60:63], a[44:47], v[120:123]
    buffer_load_dwordx4 v[132:135], v15, s[16:19], s43 offen
    s_add_u32 s43, s43, s44
    v_perm_b32 v68, v102, v102, v112
    v_perm_b32 v69, v102, v102, v113
    v_perm_b32 v70, v102, v102, v114
    v_perm_b32 v71, v102, v102, v115
    v_mov_b32 v236, 0
    v_mov_b32 v237, 0
    s_waitcnt vmcnt(9)
    v_mfma_f32_16x16x32_bf16 v[120:123], v[64:67], a[48:51], v[120:123]
    buffer_load_dwordx4 v[136:139], v15, s[16:19], s43 offen
    s_add_u32 s43, s43, s44
    v_lshlrev_b32 v10, 16, v103
    v_and_b32 v11, 0xffff0000, v103
    v_sub_f32 v10, v10, v220
    v_sub_f32 v11, v11, v220
    v_cvt_pk_bf16_f32 v103, v10, v11
    v_lshlrev_b32 v10, 16, v103
    v_and_b32 v11, 0xffff0000, v103
    v_mul_f32 v10, v10, v221
    v_mul_f32 v11, v11, v221
    v_cvt_pk_bf16_f32 v103, v10, v11
    v_perm_b32 v72, v103, v103, v108
    v_perm_b32 v73, v103, v103, v109
    v_perm_b32 v74, v103, v103, v110
    v_perm_b32 v75, v103, v103, v111
    s_mov_b64 vcc, s[56:57]
    s_waitcnt vmcnt(9)
    v_mfma_f32_16x16x32_bf16 v[120:123], v[68:71], a[52:55], v[120:123]
    buffer_load_dwordx4 v[140:143], v15, s[16:19], s43 offen
    s_add_u32 s43, s43, s44
    v_perm_b32 v76, v103, v103, v112
    v_perm_b32 v77, v103, v103, v113
    v_perm_b32 v78, v103, v103, v114
    v_perm_b32 v79, v103, v103, v115
    s_waitcnt vmcnt(9)
    v_mfma_f32_16x16x32_bf16 v[120:123], v[72:75], a[56:59], v[120:123]
    buffer_load_dwordx4 v[144:147], v15, s[16:19], s43 offen
    s_add_u32 s43, s43, s44
    v_lshlrev_b32 v10, 16, v104
    v_and_b32 v11, 0xffff0000, v104
    v_sub_f32 v10, v10, v220
    v_sub_f32 v11, v11, v220
    v_cvt_pk_bf16_f32 v104, v10, v11
    v_lshlrev_b32 v10, 16, v104
    v_and_b32 v11, 0xffff0000, v104
    v_mul_f32 v10, v10, v221
    v_mul_f32 v11, v11, v221
    v_cvt_pk_bf16_f32 v104, v10, v11
    v_perm_b32 v80, v104, v104, v108
    v_perm_b32 v81, v104, v104, v109
    v_perm_b32 v82, v104, v104, v110
    v_perm_b32 v83, v104, v104, v111
    s_waitcnt vmcnt(9)
    v_mfma_f32_16x16x32_bf16 v[120:123], v[76:79], a[60:63], v[120:123]
    buffer_load_dwordx4 v[148:151], v15, s[16:19], s43 offen
    s_add_u32 s43, s43, s44
    v_perm_b32 v84, v104, v104, v112
    v_perm_b32 v85, v104, v104, v113
    v_perm_b32 v86, v104, v104, v114
    v_perm_b32 v87, v104, v104, v115
    s_waitcnt vmcnt(9)
    v_mfma_f32_16x16x32_bf16 v[120:123], v[80:83], a[64:67], v[120:123]
    buffer_load_dwordx4 v[152:155], v15, s[16:19], s43 offen
    s_add_u32 s43, s43, s44
    v_lshlrev_b32 v10, 16, v105
    v_and_b32 v11, 0xffff0000, v105
    v_sub_f32 v10, v10, v220
    v_sub_f32 v11, v11, v220
    v_cvt_pk_bf16_f32 v105, v10, v11
    v_lshlrev_b32 v10, 16, v105
    v_and_b32 v11, 0xffff0000, v105
    v_mul_f32 v10, v10, v221
    v_mul_f32 v11, v11, v221
    v_cvt_pk_bf16_f32 v105, v10, v11
    v_perm_b32 v88, v105, v105, v108
    v_perm_b32 v89, v105, v105, v109
    v_perm_b32 v90, v105, v105, v110
    v_perm_b32 v91, v105, v105, v111
    s_waitcnt vmcnt(9)
    v_mfma_f32_16x16x32_bf16 v[120:123], v[84:87], a[68:71], v[120:123]
    buffer_load_dwordx4 v[156:159], v15, s[16:19], s43 offen
    s_add_u32 s43, s43, s44
    v_perm_b32 v92, v105, v105, v112
    v_perm_b32 v93, v105, v105, v113
    v_perm_b32 v94, v105, v105, v114
    v_perm_b32 v95, v105, v105, v115
    s_waitcnt vmcnt(9)
    v_mfma_f32_16x16x32_bf16 v[120:123], v[88:91], a[72:75], v[120:123]
    s_waitcnt vmcnt(8)
    v_mfma_f32_16x16x32_bf16 v[120:123], v[92:95], a[76:79], v[120:123]
    s_mov_b32 exec_lo, 0x00ff00ff
    s_mov_b32 exec_hi, 0xff00ff00
    s_nop 5
    ds_write_b32 v126, v120 offset:0
    ds_write_b32 v126, v121 offset:256
    ds_write_b32 v126, v122 offset:512
    ds_write_b32 v126, v123 offset:768
    s_mov_b64 exec, -1
    buffer_load_dwordx4 v[160:163], v15, s[16:19], s43 offen
    s_add_u32 s43, s43, s44
    buffer_load_dwordx4 v[164:167], v15, s[16:19], s43 offen
    s_add_u32 s43, s43, s44
    s_waitcnt lgkmcnt(0)
    s_barrier
    ds_read_b128 v[192:195], v127 offset:0
    ds_read_b128 v[196:199], v127 offset:16
    buffer_load_dwordx4 v[168:171], v15, s[16:19], s43 offen
    s_add_u32 s43, s43, s44
    buffer_load_dwordx4 v[172:175], v15, s[16:19], s43 offen
    s_add_u32 s43, s43, s44
    s_waitcnt lgkmcnt(0)
    v_add_f32 v192, v192, v193
    v_add_f32 v194, v194, v195
    v_add_f32 v196, v196, v197
    v_add_f32 v198, v198, v199
    v_add_f32 v192, v192, v194
    v_add_f32 v196, v196, v198
    v_add_f32 v192, v192, v196
    v_mov_b32 v193, v192
    v_mov_b32 v194, v192
    s_nop 0
    v_mov_b32_dpp v193, v192 row_ror:8 row_mask:0xf bank_mask:0xc
    v_mov_b32_dpp v194, v192 row_ror:8 row_mask:0xf bank_mask:0x3
    v_cvt_pk_bf16_f32 v116, v193, v194
    v_mov_b32 v117, v116
    s_nop 1
    v_permlane16_swap_b32 v116, v117
    v_mov_b32 v118, v116
    v_mov_b32 v119, v117
    s_nop 0
    v_permlane32_swap_b32 v116, v118
    v_permlane32_swap_b32 v117, v119
    buffer_load_dwordx4 v[176:179], v15, s[16:19], s43 offen
    s_add_u32 s43, s43, s44
    buffer_load_dwordx4 v[180:183], v15, s[16:19], s43 offen
    s_add_u32 s43, s43, s44
    buffer_load_dwordx4 v[184:187], v15, s[16:19], s43 offen
    s_add_u32 s43, s43, s44
    buffer_load_dwordx4 v[188:191], v15, s[16:19], s43 offen
    s_add_u32 s43, s43, s44
    s_waitcnt vmcnt(14)
    v_dot2c_f32_bf16 v222, v128, v116
    v_dot2c_f32_bf16 v222, v129, v117
    v_dot2c_f32_bf16 v222, v130, v118
    v_dot2c_f32_bf16 v222, v131, v119
    v_dot2c_f32_bf16 v223, v132, v116
    v_dot2c_f32_bf16 v223, v133, v117
    v_dot2c_f32_bf16 v223, v134, v118
    v_dot2c_f32_bf16 v223, v135, v119
    s_waitcnt vmcnt(12)
    v_dot2c_f32_bf16 v224, v136, v116
    v_dot2c_f32_bf16 v224, v137, v117
    v_add_f32_dpp v196, v222, v222 row_half_mirror row_mask:0xf bank_mask:0x5
    v_dot2c_f32_bf16 v224, v138, v118
    v_dot2c_f32_bf16 v224, v139, v119
    v_add_f32_dpp v196, v223, v223 row_half_mirror row_mask:0xf bank_mask:0xa
    v_dot2c_f32_bf16 v225, v140, v116
    v_dot2c_f32_bf16 v225, v141, v117
    v_add_f32_dpp v196, v196, v196 quad_perm:[1,0,3,2] row_mask:0xf bank_mask:0xf
    v_dot2c_f32_bf16 v225, v142, v118
    v_dot2c_f32_bf16 v225, v143, v119
    v_add_f32_dpp v196, v196, v196 quad_perm:[2,3,0,1] row_mask:0xf bank_mask:0xf
    v_cndmask_b32 v208, v208, v196, vcc
    s_waitcnt vmcnt(10)
    v_dot2c_f32_bf16 v226, v144, v116
    v_dot2c_f32_bf16 v226, v145, v117
    v_add_f32_dpp v197, v224, v224 row_half_mirror row_mask:0xf bank_mask:0x5
    v_dot2c_f32_bf16 v226, v146, v118
    v_dot2c_f32_bf16 v226, v147, v119
    v_add_f32_dpp v197, v225, v225 row_half_mirror row_mask:0xf bank_mask:0xa
    v_dot2c_f32_bf16 v227, v148, v116
    v_dot2c_f32_bf16 v227, v149, v117
    v_add_f32_dpp v197, v197, v197 quad_perm:[1,0,3,2] row_mask:0xf bank_mask:0xf
    v_dot2c_f32_bf16 v227, v150, v118
    v_dot2c_f32_bf16 v227, v151, v119
    v_add_f32_dpp v197, v197, v197 quad_perm:[2,3,0,1] row_mask:0xf bank_mask:0xf
    v_cndmask_b32 v209, v209, v197, vcc
    s_lshl_b64 vcc, vcc, 1
    s_waitcnt vmcnt(8)
    v_dot2c_f32_bf16 v228, v152, v116
    v_dot2c_f32_bf16 v228, v153, v117
    v_add_f32_dpp v196, v226, v226 row_half_mirror row_mask:0xf bank_mask:0x5
    v_dot2c_f32_bf16 v228, v154, v118
    v_dot2c_f32_bf16 v228, v155, v119
    v_add_f32_dpp v196, v227, v227 row_half_mirror row_mask:0xf bank_mask:0xa
    v_dot2c_f32_bf16 v229, v156, v116
    v_dot2c_f32_bf16 v229, v157, v117
    v_add_f32_dpp v196, v196, v196 quad_perm:[1,0,3,2] row_mask:0xf bank_mask:0xf
    v_dot2c_f32_bf16 v229, v158, v118
    v_dot2c_f32_bf16 v229, v159, v119
    v_add_f32_dpp v196, v196, v196 quad_perm:[2,3,0,1] row_mask:0xf bank_mask:0xf
    v_cndmask_b32 v208, v208, v196, vcc
    s_waitcnt vmcnt(6)
    v_dot2c_f32_bf16 v230, v160, v116
    v_dot2c_f32_bf16 v230, v161, v117
    v_add_f32_dpp v197, v228, v228 row_half_mirror row_mask:0xf bank_mask:0x5
    v_dot2c_f32_bf16 v230, v162, v118
    v_dot2c_f32_bf16 v230, v163, v119
    v_add_f32_dpp v197, v229, v229 row_half_mirror row_mask:0xf bank_mask:0xa
    v_dot2c_f32_bf16 v231, v164, v116
    v_dot2c_f32_bf16 v231, v165, v117
    v_add_f32_dpp v197, v197, v197 quad_perm:[1,0,3,2] row_mask:0xf bank_mask:0xf
    v_dot2c_f32_bf16 v231, v166, v118
    v_dot2c_f32_bf16 v231, v167, v119
    v_add_f32_dpp v197, v197, v197 quad_perm:[2,3,0,1] row_mask:0xf bank_mask:0xf
    v_cndmask_b32 v209, v209, v197, vcc
    s_lshl_b64 vcc, vcc, 1
    s_waitcnt vmcnt(4)
    v_dot2c_f32_bf16 v232, v168, v116
    v_dot2c_f32_bf16 v232, v169, v117
    v_add_f32_dpp v196, v230, v230 row_half_mirror row_mask:0xf bank_mask:0x5
    v_dot2c_f32_bf16 v232, v170, v118
    v_dot2c_f32_bf16 v232, v171, v119
    v_add_f32_dpp v196, v231, v231 row_half_mirror row_mask:0xf bank_mask:0xa
    v_dot2c_f32_bf16 v233, v172, v116
    v_dot2c_f32_bf16 v233, v173, v117
    v_add_f32_dpp v196, v196, v196 quad_perm:[1,0,3,2] row_mask:0xf bank_mask:0xf
    v_dot2c_f32_bf16 v233, v174, v118
    v_dot2c_f32_bf16 v233, v175, v119
    v_add_f32_dpp v196, v196, v196 quad_perm:[2,3,0,1] row_mask:0xf bank_mask:0xf
    v_cndmask_b32 v208, v208, v196, vcc
    s_waitcnt vmcnt(3)
    v_dot2c_f32_bf16 v234, v176, v116
    v_dot2c_f32_bf16 v234, v177, v117
    v_add_f32_dpp v197, v232, v232 row_half_mirror row_mask:0xf bank_mask:0x5
    v_dot2c_f32_bf16 v234, v178, v118
    v_dot2c_f32_bf16 v234, v179, v119
    v_add_f32_dpp v197, v233, v233 row_half_mirror row_mask:0xf bank_mask:0xa
    s_waitcnt vmcnt(2)
    v_dot2c_f32_bf16 v235, v180, v116
    v_dot2c_f32_bf16 v235, v181, v117
    v_add_f32_dpp v197, v197, v197 quad_perm:[1,0,3,2] row_mask:0xf bank_mask:0xf
    v_dot2c_f32_bf16 v235, v182, v118
    v_dot2c_f32_bf16 v235, v183, v119
    v_add_f32_dpp v197, v197, v197 quad_perm:[2,3,0,1] row_mask:0xf bank_mask:0xf
    v_cndmask_b32 v209, v209, v197, vcc
    s_lshl_b64 vcc, vcc, 1
    s_waitcnt vmcnt(1)
    v_dot2c_f32_bf16 v236, v184, v116
    v_dot2c_f32_bf16 v236, v185, v117
    v_add_f32_dpp v196, v234, v234 row_half_mirror row_mask:0xf bank_mask:0x5
    v_dot2c_f32_bf16 v236, v186, v118
    v_dot2c_f32_bf16 v236, v187, v119
    v_add_f32_dpp v196, v235, v235 row_half_mirror row_mask:0xf bank_mask:0xa
    s_waitcnt vmcnt(0)
    v_dot2c_f32_bf16 v237, v188, v116
    v_dot2c_f32_bf16 v237, v189, v117
    v_add_f32_dpp v196, v196, v196 quad_perm:[1,0,3,2] row_mask:0xf bank_mask:0xf
    v_dot2c_f32_bf16 v237, v190, v118
A_pg1:
    s_cbranch_execz LA_back
    v_dot2c_f32_bf16 v237, v191, v119
    v_add_f32_dpp v196, v196, v196 quad_perm:[2,3,0,1] row_mask:0xf bank_mask:0xf
    v_cndmask_b32 v208, v208, v196, vcc
    v_add_f32_dpp v197, v236, v236 row_half_mirror row_mask:0xf bank_mask:0x5
    s_nop 1
    v_add_f32_dpp v197, v237, v237 row_half_mirror row_mask:0xf bank_mask:0xa
    s_nop 1
    v_add_f32_dpp v197, v197, v197 quad_perm:[1,0,3,2] row_mask:0xf bank_mask:0xf
    s_nop 1
    v_add_f32_dpp v197, v197, v197 quad_perm:[2,3,0,1] row_mask:0xf bank_mask:0xf
    v_cndmask_b32 v209, v209, v197, vcc
    s_lshl_b64 vcc, vcc, 1
    s_cmp_eq_u32 s3, 3
    s_cbranch_scc0 L_nf1
    buffer_store_dwordx4 v[212:215], v211, s[4:7], s46 offen sc1
L_nf1:
    v_mov_b32 v197, v209
    v_mov_b32_dpp v209, v208 row_shl:4 row_mask:0xf bank_mask:0x5
    s_nop 0
    v_mov_b32_dpp v208, v197 row_shr:4 row_mask:0xf bank_mask:0xa
    v_cvt_pk_bf16_f32 v208, v208, v209
    ds_write_b32 v210, v208
    s_waitcnt lgkmcnt(0)
    ds_read_b128 v[204:207], v216
    s_mov_b64 exec, 0xffffff
    s_waitcnt lgkmcnt(0)
    v_mov_b32 v207, s34
    buffer_store_dwordx4 v[204:207], v211, s[4:7], s47 offen sc1
    s_mov_b64 exec, -1
    s_and_b32 s45, s36, 3
    s_lshl_b32 s45, s45, 4
    s_lshr_b32 s46, s36, 2
    s_add_u32 s45, s45, s46
    s_lshl_b32 s46, s3, 1
    s_add_u32 s45, s45, s46
    s_lshl_b32 s45, s45, 16
    v_lshlrev_b32 v9, 13, v2
    v_lshl_or_b32 v9, v3, 7, v9
    s_lshl_b32 s46, s35, 10
    s_add_u32 s45, s45, s46
    buffer_load_dword v250, v9, s[48:51], s45 offen
    s_add_u32 s45, s45, 524288
    buffer_load_dword v250, v9, s[48:51], s45 offen
    s_add_u32 s45, s45, 524288
    s_mul_i32 s45, s35, 27
    s_lshr_b32 s46, s45, 3
    s_add_u32 s45, s45, 27
    s_lshr_b32 s45, s45, 3
    s_lshr_b32 s44, s36, 1
    s_add_u32 s46, s46, s44
    s_cmp_ge_u32 s46, s45
    s_cbranch_scc1 L_fin
    v_lshrrev_b32 v1, 17, v15
    v_mul_u32_u24 v1, 69120, v1
    v_add_u32 v1, v1, v14
    s_lshl_b32 s45, s46, 7
    s_mov_b32 s40, s45
    s_movk_i32 s42, 3456
    v_lshl_add_u32 v9, v3, 3, v2
    v_lshlrev_b32 v9, 1, v9
    buffer_load_ushort v200, v9, s[28:31], s45 offen
    s_mov_b32 s43, s40
    s_lshr_b32 s45, s3, 1
    s_lshl_b32 s45, s45, 3
    v_add_u32 v134, 0, v0
    v_mul_u32_u24 v135, 52429, v134
    v_lshrrev_b32 v135, 22, v135
    v_mul_u32_u24 v136, 80, v135
    v_sub_u32 v134, v134, v136
    v_lshl_or_b32 v137, v135, 1, s45
    v_xor_b32 v134, v134, v137
    v_add_u32 v134, v134, v136
    v_lshlrev_b32 v128, 4, v134
    v_add_u32 v134, 64, v0
    v_mul_u32_u24 v135, 52429, v134
    v_lshrrev_b32 v135, 22, v135
    v_mul_u32_u24 v136, 80, v135
    v_sub_u32 v134, v134, v136
    v_lshl_or_b32 v137, v135, 1, s45
    v_xor_b32 v134, v134, v137
    v_add_u32 v134, v134, v136
    v_lshlrev_b32 v129, 4, v134
    v_add_u32 v134, 128, v0
    v_mul_u32_u24 v135, 52429, v134
    v_lshrrev_b32 v135, 22, v135
    v_mul_u32_u24 v136, 80, v135
    v_sub_u32 v134, v134, v136
    v_lshl_or_b32 v137, v135, 1, s45
    v_xor_b32 v134, v134, v137
    v_add_u32 v134, v134, v136
    v_lshlrev_b32 v130, 4, v134
    v_add_u32 v134, 192, v0
    v_mul_u32_u24 v135, 52429, v134
    v_lshrrev_b32 v135, 22, v135
    v_mul_u32_u24 v136, 80, v135
    v_sub_u32 v134, v134, v136
    v_lshl_or_b32 v137, v135, 1, s45
    v_xor_b32 v134, v134, v137
    v_add_u32 v134, v134, v136
    v_lshlrev_b32 v131, 4, v134
    v_add_u32 v134, 256, v0
    v_mul_u32_u24 v135, 52429, v134
    v_lshrrev_b32 v135, 22, v135
    v_mul_u32_u24 v136, 80, v135
    v_sub_u32 v134, v134, v136
    v_lshl_or_b32 v137, v135, 1, s45
    v_xor_b32 v134, v134, v137
    v_add_u32 v134, v134, v136
    v_lshlrev_b32 v132, 4, v134
    s_lshl_b32 s40, s46, 1
    s_add_u32 s40, s40, s39
    s_lshl_b32 s44, s40, 12
    s_mul_i32 s47, s40, 2560
    s_mul_i32 s40, s40, 40960
    s_mul_i32 s45, s3, 5120
    s_add_u32 s40, s40, s45
    s_add_u32 m0, s45, 16384
    s_mul_i32 s45, s3, 640
    s_add_u32 s47, s47, s45
    s_add_u32 s47, s47, 524288
    s_lshl_b32 s45, s3, 10
    s_add_u32 s57, s44, s45
    s_add_u32 s57, s57, 3670016
    s_mov_b32 s48, 0x7060500
    s_mov_b32 s49, 0x7060501
    buffer_load_dwordx4 v128, s[24:27], s40 offen lds
    s_add_u32 m0, m0, 1024
    s_nop 0
    buffer_load_dwordx4 v129, s[24:27], s40 offen lds
    s_add_u32 m0, m0, 1024
    s_nop 0
    buffer_load_dwordx4 v130, s[24:27], s40 offen lds
    s_add_u32 m0, m0, 1024
    s_nop 0
    buffer_load_dwordx4 v131, s[24:27], s40 offen lds
    s_add_u32 m0, m0, 1024
    s_nop 0
    buffer_load_dwordx4 v132, s[24:27], s40 offen lds
    s_add_u32 m0, m0, 16384
    s_add_u32 s40, s40, 20480
    buffer_load_dwordx4 v128, s[24:27], s40 offen lds
    s_add_u32 m0, m0, 1024
    s_nop 0
    buffer_load_dwordx4 v129, s[24:27], s40 offen lds
    s_add_u32 m0, m0, 1024
    s_nop 0
    buffer_load_dwordx4 v130, s[24:27], s40 offen lds
    s_add_u32 m0, m0, 1024
    s_nop 0
    buffer_load_dwordx4 v131, s[24:27], s40 offen lds
    s_add_u32 m0, m0, 1024
    s_nop 0
    buffer_load_dwordx4 v132, s[24:27], s40 offen lds
    buffer_load_dwordx4 a[0:3], v1, s[20:23], s43 offen
    s_add_u32 s43, s43, s42
    buffer_load_dwordx4 a[4:7], v1, s[20:23], s43 offen
    s_add_u32 s43, s43, s42
    buffer_load_dwordx4 a[8:11], v1, s[20:23], s43 offen
    s_add_u32 s43, s43, s42
    buffer_load_dwordx4 a[12:15], v1, s[20:23], s43 offen
    s_add_u32 s43, s43, s42
    buffer_load_dwordx4 a[16:19], v1, s[20:23], s43 offen
    s_add_u32 s43, s43, s42
    buffer_load_dwordx4 a[20:23], v1, s[20:23], s43 offen
    s_add_u32 s43, s43, s42
    v_bfe_u32 v134, v0, 2, 2
    v_lshrrev_b32 v135, 4, v0
    v_lshl_add_u32 v136, v135, 3, v134
    v_mul_u32_u24 v136, 1280, v136
    v_and_b32 v135, 1, v135
    v_lshl_or_b32 v134, v135, 2, v134
    v_lshlrev_b32 v134, 1, v134
    v_and_b32 v135, 1, v0
    v_lshl_add_u32 v136, v135, 3, v136
    v_add_u32 v136, 16384, v136
    v_bfe_u32 v135, v0, 1, 1
    s_mul_i32 s45, s3, 20
    v_add_u32 v135, s45, v135
    v_add_u32 v144, 0, v135
    v_xor_b32 v144, v144, v134
    v_lshl_add_u32 v144, v144, 4, v136
    v_add_u32 v145, 2, v135
    v_xor_b32 v145, v145, v134
    v_lshl_add_u32 v145, v145, 4, v136
    v_add_u32 v146, 4, v135
    v_xor_b32 v146, v146, v134
    v_lshl_add_u32 v146, v146, 4, v136
    v_add_u32 v147, 6, v135
    v_xor_b32 v147, v147, v134
    v_lshl_add_u32 v147, v147, 4, v136
    v_add_u32 v148, 8, v135
    v_xor_b32 v148, v148, v134
    v_lshl_add_u32 v148, v148, 4, v136
    v_add_u32 v149, 10, v135
    v_xor_b32 v149, v149, v134
    v_lshl_add_u32 v149, v149, 4, v136
    v_add_u32 v150, 12, v135
    v_xor_b32 v150, v150, v134
    v_lshl_add_u32 v150, v150, 4, v136
    v_add_u32 v151, 14, v135
    v_xor_b32 v151, v151, v134
    v_lshl_add_u32 v151, v151, 4, v136
    v_add_u32 v152, 16, v135
    v_xor_b32 v152, v152, v134
    v_lshl_add_u32 v152, v152, 4, v136
    v_add_u32 v153, 18, v135
    v_xor_b32 v153, v153, v134
    v_lshl_add_u32 v153, v153, 4, v136
    s_lshl_b32 s45, s3, 7
    s_add_u32 s45, s45, 8192
    v_add_u32 v9, s45, v9
    s_lshl_b32 s44, s39, 6
    s_add_u32 s45, s45, s44
    v_lshrrev_b32 v138, 4, v0
    v_lshl_add_u32 v138, v138, 4, s45
    s_waitcnt vmcnt(6)
    s_barrier
    ds_read_b64_tr_b16 a[160:161], v144 offset:0
    ds_read_b64_tr_b16 a[162:163], v144 offset:5120
    ds_read_b64_tr_b16 a[164:165], v145 offset:0
    ds_read_b64_tr_b16 a[166:167], v145 offset:5120
    ds_read_b64_tr_b16 a[168:169], v146 offset:0
    ds_read_b64_tr_b16 a[170:171], v146 offset:5120
    ds_read_b64_tr_b16 a[172:173], v147 offset:0
    ds_read_b64_tr_b16 a[174:175], v147 offset:5120
    ds_read_b64_tr_b16 a[176:177], v148 offset:0
    ds_read_b64_tr_b16 a[178:179], v148 offset:5120
    ds_read_b64_tr_b16 a[180:181], v149 offset:0
    ds_read_b64_tr_b16 a[182:183], v149 offset:5120
    ds_read_b64_tr_b16 a[184:185], v150 offset:0
    ds_read_b64_tr_b16 a[186:187], v150 offset:5120
    ds_read_b64_tr_b16 a[188:189], v151 offset:0
    ds_read_b64_tr_b16 a[190:191], v151 offset:5120
    ds_read_b64_tr_b16 a[192:193], v152 offset:0
    ds_read_b64_tr_b16 a[194:195], v152 offset:5120
    ds_read_b64_tr_b16 a[196:197], v153 offset:0
    ds_read_b64_tr_b16 a[198:199], v153 offset:5120
    s_waitcnt vmcnt(5)
    v_mfma_f32_16x16x32_bf16 v[120:123], v[16:19], a[0:3], 0
    buffer_load_dwordx4 a[24:27], v1, s[20:23], s43 offen
    s_add_u32 s43, s43, s42
    s_waitcnt vmcnt(5)
    v_mfma_f32_16x16x32_bf16 v[120:123], v[20:23], a[4:7], v[120:123]
    buffer_load_dwordx4 a[28:31], v1, s[20:23], s43 offen
    s_add_u32 s43, s43, s42
    s_waitcnt vmcnt(5)
    v_mfma_f32_16x16x32_bf16 v[120:123], v[24:27], a[8:11], v[120:123]
    buffer_load_dwordx4 a[32:35], v1, s[20:23], s43 offen
    s_add_u32 s43, s43, s42
    s_waitcnt vmcnt(5)
    v_mfma_f32_16x16x32_bf16 v[120:123], v[28:31], a[12:15], v[120:123]
    buffer_load_dwordx4 a[36:39], v1, s[20:23], s43 offen
    s_add_u32 s43, s43, s42
    s_waitcnt vmcnt(5)
    v_mfma_f32_16x16x32_bf16 v[120:123], v[32:35], a[16:19], v[120:123]
    buffer_load_dwordx4 a[40:43], v1, s[20:23], s43 offen
    s_add_u32 s43, s43, s42
    s_waitcnt vmcnt(5)
    v_mfma_f32_16x16x32_bf16 v[120:123], v[36:39], a[20:23], v[120:123]
    buffer_load_dwordx4 a[44:47], v1, s[20:23], s43 offen
    s_add_u32 s43, s43, s42
    s_waitcnt vmcnt(5)
    v_mfma_f32_16x16x32_bf16 v[120:123], v[40:43], a[24:27], v[120:123]
    buffer_load_dwordx4 a[48:51], v1, s[20:23], s43 offen
    s_add_u32 s43, s43, s42
    s_waitcnt vmcnt(5)
    v_mfma_f32_16x16x32_bf16 v[120:123], v[44:47], a[28:31], v[120:123]
    buffer_load_dwordx4 a[52:55], v1, s[20:23], s43 offen
    s_add_u32 s43, s43, s42
    s_waitcnt vmcnt(5)
    v_mfma_f32_16x16x32_bf16 v[120:123], v[48:51], a[32:35], v[120:123]
    buffer_load_dwordx4 a[56:59], v1, s[20:23], s43 offen
    s_add_u32 s43, s43, s42
    s_waitcnt vmcnt(5)
    v_mfma_f32_16x16x32_bf16 v[120:123], v[52:55], a[36:39], v[120:123]
    buffer_load_dwordx4 a[60:63], v1, s[20:23], s43 offen
    s_add_u32 s43, s43, s42
    s_waitcnt vmcnt(5)
    v_mfma_f32_16x16x32_bf16 v[120:123], v[56:59], a[40:43], v[120:123]
    buffer_load_dwordx4 a[64:67], v1, s[20:23], s43 offen
    s_add_u32 s43, s43, s42
    s_waitcnt vmcnt(5)
    v_mfma_f32_16x16x32_bf16 v[120:123], v[60:63], a[44:47], v[120:123]
    buffer_load_dwordx4 a[68:71], v1, s[20:23], s43 offen
    s_add_u32 s43, s43, s42
    s_waitcnt vmcnt(5)
    v_mfma_f32_16x16x32_bf16 v[120:123], v[64:67], a[48:51], v[120:123]
    buffer_load_dwordx4 a[72:75], v1, s[20:23], s43 offen
    s_add_u32 s43, s43, s42
    s_waitcnt vmcnt(5)
    v_mfma_f32_16x16x32_bf16 v[120:123], v[68:71], a[52:55], v[120:123]
    buffer_load_dwordx4 a[76:79], v1, s[20:23], s43 offen
    s_add_u32 s43, s43, s42
    s_waitcnt vmcnt(5)
    v_mfma_f32_16x16x32_bf16 v[120:123], v[72:75], a[56:59], v[120:123]
    s_waitcnt vmcnt(4)
    v_mfma_f32_16x16x32_bf16 v[120:123], v[76:79], a[60:63], v[120:123]
    s_waitcnt vmcnt(3)
    v_mfma_f32_16x16x32_bf16 v[120:123], v[80:83], a[64:67], v[120:123]
    s_waitcnt vmcnt(2)
    v_mfma_f32_16x16x32_bf16 v[120:123], v[84:87], a[68:71], v[120:123]
    s_waitcnt vmcnt(1)
    v_mfma_f32_16x16x32_bf16 v[120:123], v[88:91], a[72:75], v[120:123]
    s_waitcnt vmcnt(0)
    v_mfma_f32_16x16x32_bf16 v[120:123], v[92:95], a[76:79], v[120:123]
    s_mov_b32 exec_lo, 0x00ff00ff
    s_mov_b32 exec_hi, 0xff00ff00
    s_nop 5
    ds_write_b32 v126, v120 offset:6144
    ds_write_b32 v126, v121 offset:6400
    ds_write_b32 v126, v122 offset:6656
    ds_write_b32 v126, v123 offset:6912
    s_mov_b64 exec, -1
    s_waitcnt lgkmcnt(0)
    s_barrier
    ds_read_b128 v[192:195], v127 offset:6144
    ds_read_b128 v[196:199], v127 offset:6160
    s_waitcnt lgkmcnt(0)
    v_add_f32 v192, v192, v193
    v_add_f32 v194, v194, v195
    v_add_f32 v196, v196, v197
    v_add_f32 v198, v198, v199
    v_add_f32 v192, v192, v194
    v_add_f32 v196, v196, v198
    v_add_f32 v192, v192, v196
    v_cvt_pk_bf16_f32 v192, v192, v192
    v_lshlrev_b32 v192, 16, v192
    v_lshlrev_b32 v200, 16, v200
    v_add_f32 v192, v192, v200
    v_cvt_pk_bf16_f32 v192, v192, v192
    v_lshlrev_b32 v192, 16, v192
    v_max_f32 v192, 0, v192
    v_mul_f32 v192, v192, v192
    v_cvt_pk_bf16_f32 v192, v192, v192
    ds_write_b16 v9, v192
    s_waitcnt lgkmcnt(0)
    ds_read_b128 v[116:119], v138
    s_waitcnt lgkmcnt(0)
    v_mfma_f32_16x16x32_bf16 v[160:163], v[116:119], a[160:163], 0
    v_mfma_f32_16x16x32_bf16 v[164:167], v[116:119], a[164:167], 0
    v_mfma_f32_16x16x32_bf16 v[168:171], v[116:119], a[168:171], 0
    v_mfma_f32_16x16x32_bf16 v[172:175], v[116:119], a[172:175], 0
    v_mfma_f32_16x16x32_bf16 v[176:179], v[116:119], a[176:179], 0
    v_mfma_f32_16x16x32_bf16 v[180:183], v[116:119], a[180:183], 0
    v_mfma_f32_16x16x32_bf16 v[184:187], v[116:119], a[184:187], 0
    v_mfma_f32_16x16x32_bf16 v[188:191], v[116:119], a[188:191], 0
    v_mfma_f32_16x16x32_bf16 v[192:195], v[116:119], a[192:195], 0
    v_mfma_f32_16x16x32_bf16 v[196:199], v[116:119], a[196:199], 0
    v_mov_b32_dpp v200, v160 quad_perm:[0,1,2,3] row_mask:0x1 bank_mask:0x3
    v_mov_b32_dpp v201, v160 row_ror:8 row_mask:0x1 bank_mask:0x3
    v_mov_b32_dpp v202, v164 quad_perm:[0,1,2,3] row_mask:0x1 bank_mask:0x3
    v_mov_b32_dpp v203, v164 row_ror:8 row_mask:0x1 bank_mask:0x3
    v_mov_b32_dpp v201, v168 quad_perm:[0,1,2,3] row_mask:0x1 bank_mask:0xc
    v_mov_b32_dpp v200, v168 row_ror:8 row_mask:0x1 bank_mask:0xc
    v_mov_b32_dpp v203, v172 quad_perm:[0,1,2,3] row_mask:0x1 bank_mask:0xc
    v_mov_b32_dpp v202, v172 row_ror:8 row_mask:0x1 bank_mask:0xc
    v_mov_b32_dpp v200, v176 quad_perm:[0,1,2,3] row_mask:0x2 bank_mask:0x3
    v_mov_b32_dpp v201, v176 row_ror:8 row_mask:0x2 bank_mask:0x3
    v_mov_b32_dpp v202, v180 quad_perm:[0,1,2,3] row_mask:0x2 bank_mask:0x3
    v_mov_b32_dpp v203, v180 row_ror:8 row_mask:0x2 bank_mask:0x3
    v_mov_b32_dpp v201, v184 quad_perm:[0,1,2,3] row_mask:0x2 bank_mask:0xc
    v_mov_b32_dpp v200, v184 row_ror:8 row_mask:0x2 bank_mask:0xc
    v_mov_b32_dpp v203, v188 quad_perm:[0,1,2,3] row_mask:0x2 bank_mask:0xc
    v_mov_b32_dpp v202, v188 row_ror:8 row_mask:0x2 bank_mask:0xc
    v_mov_b32_dpp v200, v192 quad_perm:[0,1,2,3] row_mask:0x4 bank_mask:0x3
    v_mov_b32_dpp v201, v192 row_ror:8 row_mask:0x4 bank_mask:0x3
    v_perm_b32 v200, v200, v212, s48
    v_perm_b32 v201, v201, v212, s49
    v_mov_b32_dpp v202, v196 quad_perm:[0,1,2,3] row_mask:0x4 bank_mask:0x3
    v_mov_b32_dpp v203, v196 row_ror:8 row_mask:0x4 bank_mask:0x3
    s_mov_b32 exec_hi, 0xff
    buffer_store_dwordx4 v[200:203], v211, s[4:7], s47 offen sc1
    s_mov_b32 exec_hi, -1
    s_branch L_fin
LP_start:
    s_mov_b64 s[20:21], s[48:49]
    s_mov_b64 s[24:25], s[50:51]
    s_mov_b64 s[28:29], s[42:43]
    s_mov_b64 s[12:13], s[54:55]
    s_mov_b64 s[16:17], s[58:59]
    s_lshl_b32 s37, s35, 3
    s_add_u32 s37, s37, s36
    s_sub_u32 s37, s37, 8
    s_lshl_b32 s38, s37, 7
    s_mov_b32 s22, 4194304
    s_mov_b32 s23, s7
    s_mov_b32 s26, 5242880
    s_mov_b32 s27, s7
    s_mov_b32 s30, 4194304
    s_mov_b32 s31, s7
    v_min_u32 v5, 1, v0
    v_mul_u32_u24 v5, 0x290000, v5
    buffer_load_dword v250, v5, s[4:7], 0 offen offset:2048
    s_mov_b64 exec, 0
    s_cmp_eq_u32 s3, 3
    s_cbranch_scc1 P_pg2
    s_cmp_eq_u32 s3, 2
    s_cbranch_scc1 LP_back
LP_back:
    s_mov_b64 exec, -1
    v_xor_b32 v5, 0, v3
    v_lshlrev_b32 v5, 4, v5
    v_lshl_or_b32 v12, v2, 13, v5
    v_xor_b32 v5, 2, v3
    v_lshlrev_b32 v5, 4, v5
    v_lshl_or_b32 v13, v2, 13, v5
    v_xor_b32 v5, 4, v3
    v_lshlrev_b32 v5, 4, v5
    v_lshl_or_b32 v14, v2, 13, v5
    v_xor_b32 v5, 6, v3
    v_lshlrev_b32 v5, 4, v5
    v_lshl_or_b32 v15, v2, 13, v5
    s_lshl_b32 s43, s3, 20
    s_add_u32 s43, s43, s38
    s_lshl_b32 s44, s3, 14
    s_mov_b32 s42, 0x10000
    s_lshr_b32 s45, s3, 1
    s_lshl_b32 s45, s45, 3
    v_add_u32 v24, 0, v0
    v_mul_u32_u24 v25, 52429, v24
    v_lshrrev_b32 v25, 22, v25
    v_mul_u32_u24 v26, 80, v25
    v_sub_u32 v24, v24, v26
    v_lshl_or_b32 v27, v25, 1, s45
    v_xor_b32 v24, v24, v27
    v_add_u32 v24, v24, v26
    v_lshlrev_b32 v16, 4, v24
    v_add_u32 v24, 64, v0
    v_mul_u32_u24 v25, 52429, v24
    v_lshrrev_b32 v25, 22, v25
    v_mul_u32_u24 v26, 80, v25
    v_sub_u32 v24, v24, v26
    v_lshl_or_b32 v27, v25, 1, s45
    v_xor_b32 v24, v24, v27
    v_add_u32 v24, v24, v26
    v_lshlrev_b32 v17, 4, v24
    v_add_u32 v24, 128, v0
    v_mul_u32_u24 v25, 52429, v24
    v_lshrrev_b32 v25, 22, v25
    v_mul_u32_u24 v26, 80, v25
    v_sub_u32 v24, v24, v26
    v_lshl_or_b32 v27, v25, 1, s45
    v_xor_b32 v24, v24, v27
    v_add_u32 v24, v24, v26
    v_lshlrev_b32 v18, 4, v24
    v_add_u32 v24, 192, v0
    v_mul_u32_u24 v25, 52429, v24
    v_lshrrev_b32 v25, 22, v25
    v_mul_u32_u24 v26, 80, v25
    v_sub_u32 v24, v24, v26
    v_lshl_or_b32 v27, v25, 1, s45
    v_xor_b32 v24, v24, v27
    v_add_u32 v24, v24, v26
    v_lshlrev_b32 v19, 4, v24
    v_add_u32 v24, 256, v0
    v_mul_u32_u24 v25, 52429, v24
    v_lshrrev_b32 v25, 22, v25
    v_mul_u32_u24 v26, 80, v25
    v_sub_u32 v24, v24, v26
    v_lshl_or_b32 v27, v25, 1, s45
    v_xor_b32 v24, v24, v27
    v_add_u32 v24, v24, v26
    v_lshlrev_b32 v20, 4, v24
    s_mul_i32 s40, s37, 81920
    s_waitcnt lgkmcnt(0)
    v_bfe_u32 v24, v0, 2, 2
    v_lshrrev_b32 v25, 4, v0
    v_lshl_add_u32 v26, v25, 3, v24
    v_mul_u32_u24 v26, 1280, v26
    v_and_b32 v25, 1, v25
    v_lshl_or_b32 v24, v25, 2, v24
    v_lshlrev_b32 v24, 1, v24
    v_and_b32 v25, 1, v0
    v_lshl_add_u32 v26, v25, 3, v26
    v_add_u32 v26, 65536, v26
    v_bfe_u32 v25, v0, 1, 1
    s_mul_i32 s45, s3, 20
    v_add_u32 v25, s45, v25
    v_add_u32 v220, 0, v25
    v_xor_b32 v220, v220, v24
    v_lshl_add_u32 v220, v220, 4, v26
    v_add_u32 v221, 2, v25
    v_xor_b32 v221, v221, v24
    v_lshl_add_u32 v221, v221, 4, v26
    v_add_u32 v222, 4, v25
    v_xor_b32 v222, v222, v24
    v_lshl_add_u32 v222, v222, 4, v26
    v_add_u32 v223, 6, v25
    v_xor_b32 v223, v223, v24
    v_lshl_add_u32 v223, v223, 4, v26
    v_add_u32 v224, 8, v25
    v_xor_b32 v224, v224, v24
    v_lshl_add_u32 v224, v224, 4, v26
    v_add_u32 v225, 10, v25
    v_xor_b32 v225, v225, v24
    v_lshl_add_u32 v225, v225, 4, v26
    v_add_u32 v226, 12, v25
    v_xor_b32 v226, v226, v24
    v_lshl_add_u32 v226, v226, 4, v26
    v_add_u32 v227, 14, v25
    v_xor_b32 v227, v227, v24
    v_lshl_add_u32 v227, v227, 4, v26
    v_add_u32 v228, 16, v25
    v_xor_b32 v228, v228, v24
    v_lshl_add_u32 v228, v228, 4, v26
    v_add_u32 v229, 18, v25
    v_xor_b32 v229, v229, v24
    v_lshl_add_u32 v229, v229, 4, v26
    s_mul_i32 s34, s34, 0x9E3779B1
    s_add_u32 s34, s34, 0x7F4A7C15
    v_mov_b32 v212, s34
    v_mov_b32 v213, s34
    v_mov_b32 v214, s34
    v_mov_b32 v215, s34
    v_lshlrev_b32 v211, 4, v0
    v_and_b32 v24, 15, v0
    v_lshrrev_b32 v25, 4, v0
    v_add_u32 v26, 0, v25
    v_xor_b32 v27, v24, v26
    v_mul_u32_u24 v26, 1536, v26
    v_lshl_add_u32 v30, v27, 4, v26
    v_add_u32 v26, 4, v25
    v_xor_b32 v27, v24, v26
    v_mul_u32_u24 v26, 1536, v26
    v_lshl_add_u32 v31, v27, 4, v26
    v_add_u32 v26, 8, v25
    v_xor_b32 v27, v24, v26
    v_mul_u32_u24 v26, 1536, v26
    v_lshl_add_u32 v32, v27, 4, v26
    v_add_u32 v26, 12, v25
    v_xor_b32 v27, v24, v26
    v_mul_u32_u24 v26, 1536, v26
    v_lshl_add_u32 v33, v27, 4, v26
    v_lshrrev_b32 v26, 1, v2
    v_xor_b32 v26, v26, v3
    v_mul_u32_u24 v27, 1536, v2
    v_add_u32 v27, 256, v27
    v_lshl_add_u32 v34, v26, 4, v27
    v_xor_b32 v26, 4, v26
    v_lshl_add_u32 v35, v26, 4, v27
    v_xor_b32 v26, v24, v25
    v_lshl_add_u32 v27, v24, 8, s44
    v_add_u32 v27, 4096, v27
    v_xor_b32 v28, 0, v26
    v_lshl_add_u32 v216, v28, 4, v27
    v_xor_b32 v28, 4, v26
    v_lshl_add_u32 v217, v28, 4, v27
    v_xor_b32 v28, 8, v26
    v_lshl_add_u32 v218, v28, 4, v27
    v_xor_b32 v28, 12, v26
    v_lshl_add_u32 v219, v28, 4, v27
    v_lshrrev_b32 v26, 1, v24
    v_xor_b32 v26, v26, v25
    v_lshl_add_u32 v27, v24, 7, s44
    v_lshl_add_u32 v36, v26, 4, v27
    v_xor_b32 v26, 4, v26
    v_lshl_add_u32 v37, v26, 4, v27
    s_lshl_b32 s45, s3, 7
    s_add_u32 s45, s45, 147456
    v_and_b32 v24, 15, v0
    v_lshl_add_u32 v38, v24, 2, s45
    v_lshl_add_u32 v39, v25, 4, s45
    s_lshl_b32 s45, s3, 2
    s_add_u32 s45, s45, 147968
    v_add_u32 v40, s45, v211
    v_bfe_u32 v24, v0, 3, 1
    v_lshlrev_b32 v24, 5, v24
    v_lshl_add_u32 v24, v25, 3, v24
    v_add_u32 v24, v24, v3
    v_lshlrev_b32 v24, 4, v24
    v_add_u32 v41, 147968, v24
    v_and_b32 v42, 31, v0
    v_lshlrev_b32 v42, 12, v42
    s_lshr_b32 s46, s37, 4
    s_lshl_b32 s46, s46, 17
    s_add_u32 s46, s46, 3148800
    s_lshl_b32 s45, s35, 7
    s_add_u32 s46, s46, s45
    s_lshr_b32 s47, s37, 1
    s_mul_i32 s47, s47, 49152
    s_mul_i32 s45, s3, 384
    s_add_u32 s47, s47, s45
    s_add_u32 s47, s47, 1048576
    s_add_u32 s52, s47, 24576
    s_lshl_b32 s48, s37, 2
    s_add_u32 s48, s48, s3
    s_lshl_b32 s48, s48, 10
    s_add_u32 s48, s48, 3014656
    s_mul_i32 s49, s37, 2560
    s_mul_i32 s45, s3, 640
    s_add_u32 s49, s49, s45
    s_add_u32 s49, s49, 262144
    s_mov_b32 s56, 0x7060500
    s_mov_b32 s57, 0x7060501
    s_waitcnt vmcnt(2)
    s_waitcnt vmcnt(1)
    s_mul_i32 s45, s3, 5120
    s_add_u32 s40, s40, s45
    s_add_u32 m0, s45, 65536
    s_nop 0
    buffer_load_dwordx4 v16, s[24:27], s40 offen lds
    s_add_u32 m0, m0, 1024
    s_nop 0
    buffer_load_dwordx4 v17, s[24:27], s40 offen lds
    s_add_u32 m0, m0, 1024
    s_nop 0
    buffer_load_dwordx4 v18, s[24:27], s40 offen lds
    s_add_u32 m0, m0, 1024
    s_nop 0
    buffer_load_dwordx4 v19, s[24:27], s40 offen lds
    s_add_u32 m0, m0, 1024
    s_nop 0
    buffer_load_dwordx4 v20, s[24:27], s40 offen lds
    s_add_u32 m0, m0, 16384
    s_add_u32 s40, s40, 20480
    buffer_load_dwordx4 v16, s[24:27], s40 offen lds
    s_add_u32 m0, m0, 1024
    s_nop 0
    buffer_load_dwordx4 v17, s[24:27], s40 offen lds
    s_add_u32 m0, m0, 1024
    s_nop 0
    buffer_load_dwordx4 v18, s[24:27], s40 offen lds
    s_add_u32 m0, m0, 1024
    s_nop 0
    buffer_load_dwordx4 v19, s[24:27], s40 offen lds
    s_add_u32 m0, m0, 1024
    s_nop 0
    buffer_load_dwordx4 v20, s[24:27], s40 offen lds
    s_add_u32 m0, m0, 16384
    s_add_u32 s40, s40, 20480
    buffer_load_dwordx4 v16, s[24:27], s40 offen lds
    s_add_u32 m0, m0, 1024
    s_nop 0
    buffer_load_dwordx4 v17, s[24:27], s40 offen lds
    s_add_u32 m0, m0, 1024
    s_nop 0
    buffer_load_dwordx4 v18, s[24:27], s40 offen lds
    s_add_u32 m0, m0, 1024
    s_nop 0
    buffer_load_dwordx4 v19, s[24:27], s40 offen lds
    s_add_u32 m0, m0, 1024
    s_nop 0
    buffer_load_dwordx4 v20, s[24:27], s40 offen lds
    s_add_u32 m0, m0, 16384
    s_add_u32 s40, s40, 20480
    buffer_load_dwordx4 v16, s[24:27], s40 offen lds
    s_add_u32 m0, m0, 1024
    s_nop 0
    buffer_load_dwordx4 v17, s[24:27], s40 offen lds
    s_add_u32 m0, m0, 1024
    s_nop 0
    buffer_load_dwordx4 v18, s[24:27], s40 offen lds
    s_add_u32 m0, m0, 1024
    s_nop 0
    buffer_load_dwordx4 v19, s[24:27], s40 offen lds
    s_add_u32 m0, m0, 1024
    s_nop 0
    buffer_load_dwordx4 v20, s[24:27], s40 offen lds
    s_waitcnt vmcnt(0)
    s_mov_b32 m0, s44
    s_nop 0
    buffer_load_dwordx4 v12, s[20:23], s43 offen lds
    s_add_u32 s43, s43, s42
    s_add_u32 m0, m0, 1024
    s_nop 0
    buffer_load_dwordx4 v12, s[20:23], s43 offen lds
    s_add_u32 s43, s43, s42
    s_add_u32 m0, m0, 1024
    s_nop 0
    buffer_load_dwordx4 v13, s[20:23], s43 offen lds
    s_add_u32 s43, s43, s42
    s_add_u32 m0, m0, 1024
    s_nop 0
    buffer_load_dwordx4 v13, s[20:23], s43 offen lds
    s_add_u32 s43, s43, s42
    s_add_u32 m0, m0, 1024
    s_nop 0
    buffer_load_dwordx4 v14, s[20:23], s43 offen lds
    s_add_u32 s43, s43, s42
    s_add_u32 m0, m0, 1024
    s_nop 0
    buffer_load_dwordx4 v14, s[20:23], s43 offen lds
    s_add_u32 s43, s43, s42
    s_add_u32 m0, m0, 1024
    s_nop 0
    buffer_load_dwordx4 v15, s[20:23], s43 offen lds
    s_add_u32 s43, s43, s42
    s_add_u32 m0, m0, 1024
P_pg2:
    s_cbranch_execz LP_back
    s_nop 0
    buffer_load_dwordx4 v15, s[20:23], s43 offen lds
    s_add_u32 s43, s43, s42
    s_add_u32 m0, m0, 1024
    s_nop 0
    buffer_load_dwordx4 v12, s[20:23], s43 offen lds
    s_add_u32 s43, s43, s42
    s_add_u32 m0, m0, 1024
    s_nop 0
    buffer_load_dwordx4 v12, s[20:23], s43 offen lds
    s_add_u32 s43, s43, s42
    s_add_u32 m0, m0, 1024
    s_nop 0
    buffer_load_dwordx4 v13, s[20:23], s43 offen lds
    s_add_u32 s43, s43, s42
    s_add_u32 m0, m0, 1024
    s_nop 0
    buffer_load_dwordx4 v13, s[20:23], s43 offen lds
    s_add_u32 s43, s43, s42
    s_add_u32 m0, m0, 1024
    s_nop 0
    buffer_load_dwordx4 v14, s[20:23], s43 offen lds
    s_add_u32 s43, s43, s42
    s_add_u32 m0, m0, 1024
    s_nop 0
    buffer_load_dwordx4 v14, s[20:23], s43 offen lds
    s_add_u32 s43, s43, s42
    s_add_u32 m0, m0, 1024
    s_nop 0
    buffer_load_dwordx4 v15, s[20:23], s43 offen lds
    s_add_u32 s43, s43, s42
    s_add_u32 m0, m0, 1024
    s_nop 0
    buffer_load_dwordx4 v15, s[20:23], s43 offen lds
    s_barrier
    ds_read_b64_tr_b16 a[64:65], v220 offset:0
    ds_read_b64_tr_b16 a[66:67], v220 offset:5120
    ds_read_b64_tr_b16 a[68:69], v220 offset:40960
    ds_read_b64_tr_b16 a[70:71], v220 offset:46080
    ds_read_b64_tr_b16 a[72:73], v221 offset:0
    ds_read_b64_tr_b16 a[74:75], v221 offset:5120
    ds_read_b64_tr_b16 a[76:77], v221 offset:40960
    ds_read_b64_tr_b16 a[78:79], v221 offset:46080
    ds_read_b64_tr_b16 a[80:81], v222 offset:0
    ds_read_b64_tr_b16 a[82:83], v222 offset:5120
    ds_read_b64_tr_b16 a[84:85], v222 offset:40960
    ds_read_b64_tr_b16 a[86:87], v222 offset:46080
    ds_read_b64_tr_b16 a[88:89], v223 offset:0
    ds_read_b64_tr_b16 a[90:91], v223 offset:5120
    ds_read_b64_tr_b16 a[92:93], v223 offset:40960
    ds_read_b64_tr_b16 a[94:95], v223 offset:46080
    ds_read_b64_tr_b16 a[96:97], v224 offset:0
    ds_read_b64_tr_b16 a[98:99], v224 offset:5120
    ds_read_b64_tr_b16 a[100:101], v224 offset:40960
    ds_read_b64_tr_b16 a[102:103], v224 offset:46080
    ds_read_b64_tr_b16 a[104:105], v225 offset:0
    ds_read_b64_tr_b16 a[106:107], v225 offset:5120
    ds_read_b64_tr_b16 a[108:109], v225 offset:40960
    ds_read_b64_tr_b16 a[110:111], v225 offset:46080
    ds_read_b64_tr_b16 a[112:113], v226 offset:0
    ds_read_b64_tr_b16 a[114:115], v226 offset:5120
    ds_read_b64_tr_b16 a[116:117], v226 offset:40960
    ds_read_b64_tr_b16 a[118:119], v226 offset:46080
    ds_read_b64_tr_b16 a[120:121], v227 offset:0
    ds_read_b64_tr_b16 a[122:123], v227 offset:5120
    ds_read_b64_tr_b16 a[124:125], v227 offset:40960
    ds_read_b64_tr_b16 a[126:127], v227 offset:46080
    ds_read_b64_tr_b16 a[128:129], v228 offset:0
    ds_read_b64_tr_b16 a[130:131], v228 offset:5120
    ds_read_b64_tr_b16 a[132:133], v228 offset:40960
    ds_read_b64_tr_b16 a[134:135], v228 offset:46080
    ds_read_b64_tr_b16 a[136:137], v229 offset:0
    ds_read_b64_tr_b16 a[138:139], v229 offset:5120
    ds_read_b64_tr_b16 a[140:141], v229 offset:40960
    ds_read_b64_tr_b16 a[142:143], v229 offset:46080
    v_lshrrev_b32 v25, 4, v0
    v_bfe_u32 v24, v0, 2, 2
    v_lshlrev_b32 v26, 11, v24
    v_lshl_add_u32 v26, v25, 7, v26
    v_and_b32 v27, 1, v0
    v_lshl_add_u32 v26, v27, 3, v26
    v_add_u32 v26, s44, v26
    v_bfe_u32 v27, v0, 1, 1
    v_lshlrev_b32 v24, 1, v24
    v_xor_b32 v27, v27, v24
    s_waitcnt vmcnt(0)
    v_xor_b32 v28, 0, v27
    v_lshl_add_u32 v28, v28, 4, v26
    ds_read_b64_tr_b16 a[0:1], v28 offset:0
    ds_read_b64_tr_b16 a[2:3], v28 offset:8192
    ds_read_b64_tr_b16 a[4:5], v28 offset:512
    ds_read_b64_tr_b16 a[6:7], v28 offset:8704
    ds_read_b64_tr_b16 a[8:9], v28 offset:1024
    ds_read_b64_tr_b16 a[10:11], v28 offset:9216
    ds_read_b64_tr_b16 a[12:13], v28 offset:1536
    ds_read_b64_tr_b16 a[14:15], v28 offset:9728
    s_waitcnt lgkmcnt(4)
    v_xor_b32 v28, 2, v27
    v_lshl_add_u32 v28, v28, 4, v26
    ds_read_b64_tr_b16 a[16:17], v28 offset:0
    ds_read_b64_tr_b16 a[18:19], v28 offset:8192
    ds_read_b64_tr_b16 a[20:21], v28 offset:512
    ds_read_b64_tr_b16 a[22:23], v28 offset:8704
    ds_read_b64_tr_b16 a[24:25], v28 offset:1024
    ds_read_b64_tr_b16 a[26:27], v28 offset:9216
    ds_read_b64_tr_b16 a[28:29], v28 offset:1536
    ds_read_b64_tr_b16 a[30:31], v28 offset:9728
    s_waitcnt lgkmcnt(4)
    v_xor_b32 v28, 4, v27
    v_lshl_add_u32 v28, v28, 4, v26
    ds_read_b64_tr_b16 a[32:33], v28 offset:0
    ds_read_b64_tr_b16 a[34:35], v28 offset:8192
    ds_read_b64_tr_b16 a[36:37], v28 offset:512
    ds_read_b64_tr_b16 a[38:39], v28 offset:8704
    ds_read_b64_tr_b16 a[40:41], v28 offset:1024
    ds_read_b64_tr_b16 a[42:43], v28 offset:9216
    ds_read_b64_tr_b16 a[44:45], v28 offset:1536
    ds_read_b64_tr_b16 a[46:47], v28 offset:9728
    s_waitcnt lgkmcnt(4)
    v_xor_b32 v28, 6, v27
    v_lshl_add_u32 v28, v28, 4, v26
    ds_read_b64_tr_b16 a[48:49], v28 offset:0
    ds_read_b64_tr_b16 a[50:51], v28 offset:8192
    ds_read_b64_tr_b16 a[52:53], v28 offset:512
    ds_read_b64_tr_b16 a[54:55], v28 offset:8704
    ds_read_b64_tr_b16 a[56:57], v28 offset:1024
    ds_read_b64_tr_b16 a[58:59], v28 offset:9216
    ds_read_b64_tr_b16 a[60:61], v28 offset:1536
    ds_read_b64_tr_b16 a[62:63], v28 offset:9728
    s_waitcnt lgkmcnt(4)
    s_waitcnt lgkmcnt(0)
    s_mov_b32 s51, 200000
    s_mov_b32 m0, s44
L_phP:
    s_cmp_eq_u32 s3, 0
    s_cbranch_scc0 LP_wait
    s_mov_b32 s45, 200000
LP_poll:
    buffer_load_dword v43, v42, s[4:7], s46 offen sc1
    s_sub_u32 s45, s45, 1
    s_cbranch_scc1 LP_poll_d
    s_waitcnt vmcnt(0)
    v_cmp_ne_u32 vcc, s34, v43
    s_cbranch_vccnz LP_poll
LP_poll_d:
LP_wait:
    s_barrier
LP_retry:
    buffer_load_dwordx4 v34, s[4:7], s47 offen sc1 lds
    s_add_u32 m0, m0, 1024
    s_add_u32 s45, s47, 12288
    buffer_load_dwordx4 v35, s[4:7], s45 offen sc1 lds
    s_add_u32 m0, m0, 1024
    s_nop 0
    buffer_load_dwordx4 v34, s[4:7], s52 offen sc1 lds
    s_add_u32 m0, m0, 1024
    s_add_u32 s45, s52, 12288
    buffer_load_dwordx4 v35, s[4:7], s45 offen sc1 lds
    s_add_u32 m0, m0, 1024
    s_nop 0
    buffer_load_dwordx4 v30, s[4:7], s47 offen sc1 lds
    s_add_u32 m0, m0, 1024
    s_nop 0
    buffer_load_dwordx4 v31, s[4:7], s47 offen sc1 lds
    s_add_u32 m0, m0, 1024
    s_nop 0
    buffer_load_dwordx4 v32, s[4:7], s47 offen sc1 lds
    s_add_u32 m0, m0, 1024
    s_nop 0
    buffer_load_dwordx4 v33, s[4:7], s47 offen sc1 lds
    s_add_u32 m0, m0, 1024
    s_nop 0
    buffer_load_dwordx4 v30, s[4:7], s52 offen sc1 lds
    s_add_u32 m0, m0, 1024
    s_nop 0
    buffer_load_dwordx4 v31, s[4:7], s52 offen sc1 lds
    s_add_u32 m0, m0, 1024
    s_nop 0
    buffer_load_dwordx4 v32, s[4:7], s52 offen sc1 lds
    s_add_u32 m0, m0, 1024
    s_nop 0
    buffer_load_dwordx4 v33, s[4:7], s52 offen sc1 lds
    s_waitcnt vmcnt(8)
    ds_read_b128 v[68:71], v37 offset:0
    ds_read_b128 v[92:95], v37 offset:2048
    ds_read_b128 v[64:67], v36 offset:0
    ds_read_b128 v[88:91], v36 offset:2048
    s_waitcnt lgkmcnt(2)
    v_max_f32 v45, v68, v92
    v_xor_b32 v44, v71, v212
    v_bitop3_b32 v44, v44, v95, v212 bitop3:0xf6
    v_max_f32_dpp v45, v45, v45 quad_perm:[1,0,3,2] row_mask:0xf bank_mask:0xf
    s_nop 1
    v_max_f32_dpp v45, v45, v45 quad_perm:[2,3,0,1] row_mask:0xf bank_mask:0xf
    s_nop 1
    v_max_f32_dpp v45, v45, v45 row_half_mirror row_mask:0xf bank_mask:0xf
    s_nop 1
    v_max_f32_dpp v45, v45, v45 row_mirror row_mask:0xf bank_mask:0xf
    v_sub_f32 v46, v68, v45
    v_sub_f32 v47, v92, v45
    v_exp_f32 v46, v46
    v_exp_f32 v47, v47
    s_waitcnt lgkmcnt(0)
    v_bitop3_b32 v44, v44, v67, v212 bitop3:0xf6
    v_mul_f32 v45, v46, v69
    v_fmac_f32 v45, v47, v93
    v_bitop3_b32 v44, v44, v91, v212 bitop3:0xf6
    s_nop 0
    v_add_f32_dpp v45, v45, v45 quad_perm:[1,0,3,2] row_mask:0xf bank_mask:0xf
    s_nop 1
    v_add_f32_dpp v45, v45, v45 quad_perm:[2,3,0,1] row_mask:0xf bank_mask:0xf
    s_nop 1
    v_add_f32_dpp v45, v45, v45 row_half_mirror row_mask:0xf bank_mask:0xf
    s_nop 1
    v_add_f32_dpp v45, v45, v45 row_mirror row_mask:0xf bank_mask:0xf
    s_waitcnt vmcnt(4)
    ds_read_b128 v[48:51], v216 offset:0
    ds_read_b128 v[52:55], v217 offset:0
    ds_read_b128 v[56:59], v218 offset:0
    ds_read_b128 v[60:63], v219 offset:0
    v_rcp_f32 v45, v45
    s_nop 0
    v_mul_f32 v46, v46, v45
    v_mul_f32 v47, v47, v45
    ds_write_b32 v38, v46
    ds_write_b32 v38, v47 offset:64
    s_waitcnt lgkmcnt(5)
    v_bitop3_b32 v44, v44, v51, v212 bitop3:0xf6
    v_mov_b32 v51, v64
    s_waitcnt lgkmcnt(4)
    v_bitop3_b32 v44, v44, v55, v212 bitop3:0xf6
    v_mov_b32 v55, v65
    v_mfma_f32_16x16x32_bf16 v[96:99], v[48:51], a[0:3], 0
    s_waitcnt lgkmcnt(3)
    v_bitop3_b32 v44, v44, v59, v212 bitop3:0xf6
    v_mov_b32 v59, v66
    v_mfma_f32_16x16x32_bf16 v[100:103], v[48:51], a[16:19], 0
    s_waitcnt lgkmcnt(2)
    v_bitop3_b32 v44, v44, v63, v212 bitop3:0xf6
    v_mov_b32 v63, v70
    v_mfma_f32_16x16x32_bf16 v[104:107], v[48:51], a[32:35], 0
    s_waitcnt lgkmcnt(0)
    ds_read_b128 v[128:131], v39
    ds_read_b128 v[132:135], v39 offset:64
    v_mfma_f32_16x16x32_bf16 v[108:111], v[48:51], a[48:51], 0
    v_mfma_f32_16x16x32_bf16 v[96:99], v[52:55], a[4:7], v[96:99]
    v_mfma_f32_16x16x32_bf16 v[100:103], v[52:55], a[20:23], v[100:103]
    v_mfma_f32_16x16x32_bf16 v[104:107], v[52:55], a[36:39], v[104:107]
    v_mfma_f32_16x16x32_bf16 v[108:111], v[52:55], a[52:55], v[108:111]
    v_mfma_f32_16x16x32_bf16 v[96:99], v[56:59], a[8:11], v[96:99]
    v_mfma_f32_16x16x32_bf16 v[100:103], v[56:59], a[24:27], v[100:103]
    s_waitcnt vmcnt(0)
    ds_read_b128 v[72:75], v216 offset:4096
    ds_read_b128 v[76:79], v217 offset:4096
    ds_read_b128 v[80:83], v218 offset:4096
    ds_read_b128 v[84:87], v219 offset:4096
    v_mfma_f32_16x16x32_bf16 v[104:107], v[56:59], a[40:43], v[104:107]
    v_mfma_f32_16x16x32_bf16 v[108:111], v[56:59], a[56:59], v[108:111]
    v_mfma_f32_16x16x32_bf16 v[96:99], v[60:63], a[12:15], v[96:99]
    v_mfma_f32_16x16x32_bf16 v[100:103], v[60:63], a[28:31], v[100:103]
    v_mfma_f32_16x16x32_bf16 v[104:107], v[60:63], a[44:47], v[104:107]
    s_waitcnt lgkmcnt(2)
    v_bitop3_b32 v44, v44, v75, v212 bitop3:0xf6
    v_mov_b32 v75, v88
    v_bitop3_b32 v44, v44, v79, v212 bitop3:0xf6
    v_mov_b32 v79, v89
    v_mfma_f32_16x16x32_bf16 v[108:111], v[60:63], a[60:63], v[108:111]
    s_waitcnt lgkmcnt(0)
    v_bitop3_b32 v44, v44, v83, v212 bitop3:0xf6
    v_mov_b32 v83, v90
    v_bitop3_b32 v44, v44, v87, v212 bitop3:0xf6
    v_mov_b32 v87, v94
    v_mfma_f32_16x16x32_bf16 v[112:115], v[72:75], a[0:3], 0
    v_cmp_ne_u32 vcc, 0, v44
    v_mfma_f32_16x16x32_bf16 v[112:115], v[76:79], a[4:7], v[112:115]
    v_mfma_f32_16x16x32_bf16 v[112:115], v[80:83], a[8:11], v[112:115]
    s_cbranch_vccnz LP_bad
LP_ok:
    v_mfma_f32_16x16x32_bf16 v[112:115], v[84:87], a[12:15], v[112:115]
    v_mul_f32 v136, v128, v96
    v_fmac_f32 v136, v129, v97
    v_mfma_f32_16x16x32_bf16 v[116:119], v[72:75], a[16:19], 0
    v_fmac_f32 v136, v130, v98
    v_fmac_f32 v136, v131, v99
    v_mfma_f32_16x16x32_bf16 v[116:119], v[76:79], a[20:23], v[116:119]
    v_mul_f32 v137, v128, v100
    v_fmac_f32 v137, v129, v101
    v_mfma_f32_16x16x32_bf16 v[116:119], v[80:83], a[24:27], v[116:119]
    v_fmac_f32 v137, v130, v102
    v_fmac_f32 v137, v131, v103
    v_mfma_f32_16x16x32_bf16 v[116:119], v[84:87], a[28:31], v[116:119]
    v_mul_f32 v138, v128, v104
    v_fmac_f32 v138, v129, v105
    v_mfma_f32_16x16x32_bf16 v[120:123], v[72:75], a[32:35], 0
    v_fmac_f32 v138, v130, v106
    v_fmac_f32 v138, v131, v107
    v_mfma_f32_16x16x32_bf16 v[120:123], v[76:79], a[36:39], v[120:123]
    v_mul_f32 v139, v128, v108
    v_fmac_f32 v139, v129, v109
    v_mfma_f32_16x16x32_bf16 v[120:123], v[80:83], a[40:43], v[120:123]
    v_fmac_f32 v139, v130, v110
    v_fmac_f32 v139, v131, v111
    v_mfma_f32_16x16x32_bf16 v[120:123], v[84:87], a[44:47], v[120:123]
    v_fmac_f32 v136, v132, v112
    v_fmac_f32 v136, v133, v113
    v_mfma_f32_16x16x32_bf16 v[124:127], v[72:75], a[48:51], 0
    v_fmac_f32 v136, v134, v114
    v_fmac_f32 v136, v135, v115
    v_mfma_f32_16x16x32_bf16 v[124:127], v[76:79], a[52:55], v[124:127]
    v_fmac_f32 v137, v132, v116
    v_fmac_f32 v137, v133, v117
    v_mfma_f32_16x16x32_bf16 v[124:127], v[80:83], a[56:59], v[124:127]
    v_fmac_f32 v137, v134, v118
    v_fmac_f32 v137, v135, v119
    v_mfma_f32_16x16x32_bf16 v[124:127], v[84:87], a[60:63], v[124:127]
    v_fmac_f32 v138, v132, v120
    v_fmac_f32 v138, v133, v121
    v_fmac_f32 v138, v134, v122
    v_fmac_f32 v138, v135, v123
    s_cmp_eq_u32 s3, 3
    s_cbranch_scc0 L_nf2
    buffer_store_dwordx4 v[212:215], v211, s[4:7], s48 offen sc1
L_nf2:
    v_permlane32_swap_b32 v136, v138
    v_add_f32 v136, v136, v138
    v_fmac_f32 v139, v132, v124
    v_fmac_f32 v139, v133, v125
    v_fmac_f32 v139, v134, v126
    v_fmac_f32 v139, v135, v127
    s_nop 1
    v_permlane32_swap_b32 v137, v139
    v_add_f32 v137, v137, v139
    s_nop 1
    v_permlane16_swap_b32 v136, v137
    v_add_f32 v136, v136, v137
    ds_write_b32 v40, v136
    s_waitcnt lgkmcnt(0)
    s_barrier
    ds_read_b128 v[140:143], v41
    s_waitcnt lgkmcnt(0)
    v_add_f32 v140, v140, v141
    v_add_f32 v142, v142, v143
    v_add_f32 v140, v140, v142
    s_nop 1
    v_mov_b32_dpp v141, v140 quad_perm:[1,0,3,2] row_mask:0xf bank_mask:0xf
    v_cvt_pk_bf16_f32 v140, v140, v141
    s_nop 1
    v_mov_b32_dpp v144, v140 row_newbcast:0 row_mask:0xf bank_mask:0xf
    v_mov_b32_dpp v145, v140 row_newbcast:2 row_mask:0xf bank_mask:0xf
    v_mov_b32_dpp v146, v140 row_newbcast:4 row_mask:0xf bank_mask:0xf
    v_mov_b32_dpp v147, v140 row_newbcast:6 row_mask:0xf bank_mask:0xf
    v_mov_b32_dpp v148, v140 row_newbcast:8 row_mask:0xf bank_mask:0xf
    v_mov_b32_dpp v149, v140 row_newbcast:10 row_mask:0xf bank_mask:0xf
    v_mfma_f32_16x16x32_bf16 v[152:155], v[144:147], a[64:67], 0
    v_mov_b32_dpp v150, v140 row_newbcast:12 row_mask:0xf bank_mask:0xf
    v_mov_b32_dpp v151, v140 row_newbcast:14 row_mask:0xf bank_mask:0xf
    v_mfma_f32_16x16x32_bf16 v[156:159], v[144:147], a[72:75], 0
    s_nop 0
    v_mfma_f32_16x16x32_bf16 v[152:155], v[148:151], a[68:71], v[152:155]
    v_mfma_f32_16x16x32_bf16 v[156:159], v[148:151], a[76:79], v[156:159]
    v_mfma_f32_16x16x32_bf16 v[160:163], v[144:147], a[80:83], 0
    v_mfma_f32_16x16x32_bf16 v[160:163], v[148:151], a[84:87], v[160:163]
    v_mfma_f32_16x16x32_bf16 v[164:167], v[144:147], a[88:91], 0
    s_nop 3
    v_mov_b32_dpp v192, v152 quad_perm:[0,1,2,3] row_mask:0x1 bank_mask:0x3
    v_mfma_f32_16x16x32_bf16 v[164:167], v[148:151], a[92:95], v[164:167]
    v_mov_b32_dpp v193, v152 row_ror:8 row_mask:0x1 bank_mask:0x3
    v_mfma_f32_16x16x32_bf16 v[168:171], v[144:147], a[96:99], 0
    v_mov_b32_dpp v194, v156 quad_perm:[0,1,2,3] row_mask:0x1 bank_mask:0x3
    v_mfma_f32_16x16x32_bf16 v[168:171], v[148:151], a[100:103], v[168:171]
    v_mov_b32_dpp v195, v156 row_ror:8 row_mask:0x1 bank_mask:0x3
    v_mfma_f32_16x16x32_bf16 v[172:175], v[144:147], a[104:107], 0
    v_mov_b32_dpp v193, v160 quad_perm:[0,1,2,3] row_mask:0x1 bank_mask:0xc
    v_mfma_f32_16x16x32_bf16 v[172:175], v[148:151], a[108:111], v[172:175]
    v_mov_b32_dpp v192, v160 row_ror:8 row_mask:0x1 bank_mask:0xc
    v_mfma_f32_16x16x32_bf16 v[176:179], v[144:147], a[112:115], 0
    v_mov_b32_dpp v195, v164 quad_perm:[0,1,2,3] row_mask:0x1 bank_mask:0xc
    v_mfma_f32_16x16x32_bf16 v[176:179], v[148:151], a[116:119], v[176:179]
    v_mov_b32_dpp v194, v164 row_ror:8 row_mask:0x1 bank_mask:0xc
    v_mfma_f32_16x16x32_bf16 v[180:183], v[144:147], a[120:123], 0
    v_mov_b32_dpp v192, v168 quad_perm:[0,1,2,3] row_mask:0x2 bank_mask:0x3
    v_mfma_f32_16x16x32_bf16 v[180:183], v[148:151], a[124:127], v[180:183]
    v_mov_b32_dpp v193, v168 row_ror:8 row_mask:0x2 bank_mask:0x3
    v_mfma_f32_16x16x32_bf16 v[184:187], v[144:147], a[128:131], 0
    v_mov_b32_dpp v194, v172 quad_perm:[0,1,2,3] row_mask:0x2 bank_mask:0x3
    v_mfma_f32_16x16x32_bf16 v[184:187], v[148:151], a[132:135], v[184:187]
    v_mov_b32_dpp v195, v172 row_ror:8 row_mask:0x2 bank_mask:0x3
    v_mfma_f32_16x16x32_bf16 v[188:191], v[144:147], a[136:139], 0
    v_mov_b32_dpp v193, v176 quad_perm:[0,1,2,3] row_mask:0x2 bank_mask:0xc
    v_mfma_f32_16x16x32_bf16 v[188:191], v[148:151], a[140:143], v[188:191]
    v_mov_b32_dpp v192, v176 row_ror:8 row_mask:0x2 bank_mask:0xc
    v_mov_b32_dpp v195, v180 quad_perm:[0,1,2,3] row_mask:0x2 bank_mask:0xc
    v_mov_b32_dpp v194, v180 row_ror:8 row_mask:0x2 bank_mask:0xc
    s_nop 0
    v_mov_b32_dpp v192, v184 quad_perm:[0,1,2,3] row_mask:0x4 bank_mask:0x3
    v_mov_b32_dpp v193, v184 row_ror:8 row_mask:0x4 bank_mask:0x3
    v_perm_b32 v192, v192, v212, s56
    v_perm_b32 v193, v193, v212, s57
    v_mov_b32_dpp v194, v188 quad_perm:[0,1,2,3] row_mask:0x4 bank_mask:0x3
    v_mov_b32_dpp v195, v188 row_ror:8 row_mask:0x4 bank_mask:0x3
    s_mov_b32 exec_hi, 0xff
    buffer_store_dwordx4 v[192:195], v211, s[4:7], s49 offen sc1
    s_mov_b32 exec_hi, -1
    s_branch L_fin
LY_start:
    s_mov_b64 s[20:21], s[42:43]
    s_mov_b64 s[24:25], s[60:61]
    s_mov_b64 s[28:29], s[62:63]
    s_mov_b64 s[12:13], s[54:55]
    s_mov_b64 s[16:17], s[58:59]
    s_mov_b64 s[60:61], s[48:49]
    s_sub_u32 s39, s36, 16
    s_lshr_b32 s37, s39, 2
    s_lshl_b32 s45, s35, 2
    s_add_u32 s37, s37, s45
    s_and_b32 s38, s39, 3
    s_mov_b32 s55, s3
    s_add_u32 s3, s3, s38
    s_and_b32 s3, s3, 3
    v_lshlrev_b32 v211, 4, v0
    v_min_u32 v5, 1, v0
    v_mul_u32_u24 v5, 0x290000, v5
    buffer_load_dword v250, v5, s[4:7], 0 offen offset:2048
    s_mov_b64 exec, 0
    s_cmp_eq_u32 s3, 3
    s_cbranch_scc1 Y_pg3
    s_cmp_eq_u32 s3, 2
    s_cbranch_scc1 Y_pg4
    s_cmp_eq_u32 s3, 1
    s_cbranch_scc1 LY_back
LY_back:
    s_mov_b64 exec, -1
    s_mov_b32 s26, 1280
    s_mov_b32 s27, s7
    s_mov_b32 s30, 1280
    s_mov_b32 s31, s7
    s_mov_b32 s62, 4194304
    s_mov_b32 s63, s7
    s_mov_b32 s22, 131072
    s_mov_b32 s23, s7
    s_lshl_b32 s41, s37, 17
    s_lshl_b32 s42, s3, 15
    s_mov_b32 s43, 0
    s_mov_b32 s44, 0
    s_add_u32 s20, s20, s41
    s_addc_u32 s21, s21, 0
    v_and_b32 v8, 15, v0
    v_lshlrev_b32 v43, 12, v8
    s_lshl_b32 s54, s38, 16
    s_add_u32 s54, s54, 2755584
    s_lshl_b32 s45, s35, 7
    s_add_u32 s54, s54, s45
    s_xor_b32 s40, s43, s38
    s_lshl_b32 s41, s40, 13
    s_add_u32 m0, s41, s42
    s_xor_b32 s41, s40, s3
    s_and_b32 s41, s41, 1
    s_lshl_b32 s41, s41, 1
    s_lshr_b32 s40, s40, 1
    s_or_b32 s41, s41, s40
    s_lshl_b32 s41, s41, 6
    v_xor_b32 v5, s41, v211
    buffer_load_dwordx4 v5, s[20:23], m0 offen lds
    s_add_u32 m0, m0, 1024
    s_waitcnt lgkmcnt(0)
    s_mul_i32 s34, s34, 0x9E3779B1
    s_add_u32 s34, s34, 0x7F4A7C15
    v_mov_b32 v212, s34
    v_mov_b32 v213, s34
    v_mov_b32 v214, s34
    v_mov_b32 v215, s34
    v_and_b32 v8, 15, v0
    v_xor_b32 v6, 16, v5
    buffer_load_dwordx4 v6, s[20:23], m0 offen lds
    s_add_u32 m0, m0, 1024
    v_lshrrev_b32 v9, 4, v0
    s_lshr_b32 s45, s38, 1
    s_lshl_b32 s46, s45, 14
    s_add_u32 s46, s46, s42
    s_and_b32 s47, s3, 1
    s_lshl_b32 s47, s47, 1
    s_or_b32 s45, s45, s47
    s_lshl_b32 s45, s45, 2
    v_xor_b32 v6, 32, v5
    buffer_load_dwordx4 v6, s[20:23], m0 offen lds
    s_add_u32 m0, m0, 1024
    v_xor_b32 v10, s45, v8
    v_xor_b32 v10, v10, v9
    v_lshl_add_u32 v11, v8, 10, s46
    v_xor_b32 v12, 0, v10
    v_lshl_add_u32 v16, v12, 4, v11
    v_xor_b32 v20, 16448, v16
    v_xor_b32 v12, 4, v10
    v_lshl_add_u32 v17, v12, 4, v11
    v_xor_b32 v6, 48, v5
    buffer_load_dwordx4 v6, s[20:23], m0 offen lds
    s_add_u32 m0, m0, 1024
    v_xor_b32 v21, 16448, v17
    v_xor_b32 v12, 8, v10
    v_lshl_add_u32 v18, v12, 4, v11
    v_xor_b32 v22, 16448, v18
    v_xor_b32 v12, 12, v10
    v_lshl_add_u32 v19, v12, 4, v11
    v_xor_b32 v23, 16448, v19
    v_add_u32 v10, 0, v0
    v_xor_b32 v6, 64, v5
    buffer_load_dwordx4 v6, s[20:23], m0 offen lds
    s_add_u32 m0, m0, 1024
    v_mul_u32_u24 v11, 43691, v10
    v_lshrrev_b32 v11, 22, v11
    v_mul_u32_u24 v12, 96, v11
    v_sub_u32 v10, v10, v12
    v_lshl_add_u32 v11, s3, 2, v11
    v_xor_b32 v10, v10, v11
    v_mul_u32_u24 v11, 1536, v11
    v_lshl_add_u32 v24, v10, 4, v11
    v_xor_b32 v6, 80, v5
    buffer_load_dwordx4 v6, s[20:23], m0 offen lds
    s_add_u32 m0, m0, 1024
    v_add_u32 v10, 64, v0
    v_mul_u32_u24 v11, 43691, v10
    v_lshrrev_b32 v11, 22, v11
    v_mul_u32_u24 v12, 96, v11
    v_sub_u32 v10, v10, v12
    v_lshl_add_u32 v11, s3, 2, v11
    v_xor_b32 v10, v10, v11
    v_mul_u32_u24 v11, 1536, v11
    v_xor_b32 v6, 96, v5
    buffer_load_dwordx4 v6, s[20:23], m0 offen lds
    s_add_u32 m0, m0, 1024
    v_lshl_add_u32 v25, v10, 4, v11
    v_add_u32 v10, 128, v0
    v_mul_u32_u24 v11, 43691, v10
    v_lshrrev_b32 v11, 22, v11
    v_mul_u32_u24 v12, 96, v11
    v_sub_u32 v10, v10, v12
    v_lshl_add_u32 v11, s3, 2, v11
    v_xor_b32 v10, v10, v11
    v_xor_b32 v6, 112, v5
    buffer_load_dwordx4 v6, s[20:23], m0 offen lds
    v_mul_u32_u24 v11, 1536, v11
    v_lshl_add_u32 v26, v10, 4, v11
    v_add_u32 v10, 192, v0
    v_mul_u32_u24 v11, 43691, v10
    v_lshrrev_b32 v11, 22, v11
    v_mul_u32_u24 v12, 96, v11
    v_sub_u32 v10, v10, v12
    v_lshl_add_u32 v11, s3, 2, v11
    s_add_u32 s43, s43, 1
    s_xor_b32 s40, s43, s38
    s_lshl_b32 s41, s40, 13
    s_add_u32 m0, s41, s42
    s_xor_b32 s41, s40, s3
    s_and_b32 s41, s41, 1
    s_lshl_b32 s41, s41, 1
    s_lshr_b32 s40, s40, 1
    s_or_b32 s41, s41, s40
    s_lshl_b32 s41, s41, 6
    v_xor_b32 v5, s41, v211
    buffer_load_dwordx4 v5, s[20:23], m0 offen lds
    s_add_u32 m0, m0, 1024
    v_xor_b32 v10, v10, v11
    v_mul_u32_u24 v11, 1536, v11
    v_lshl_add_u32 v27, v10, 4, v11
    v_add_u32 v10, 256, v0
    v_mul_u32_u24 v11, 43691, v10
    v_lshrrev_b32 v11, 22, v11
    v_mul_u32_u24 v12, 96, v11
    v_sub_u32 v10, v10, v12
    v_xor_b32 v6, 16, v5
    buffer_load_dwordx4 v6, s[20:23], m0 offen lds
    s_add_u32 m0, m0, 1024
    v_lshl_add_u32 v11, s3, 2, v11
    v_xor_b32 v10, v10, v11
    v_mul_u32_u24 v11, 1536, v11
    v_lshl_add_u32 v28, v10, 4, v11
    v_add_u32 v10, 320, v0
    v_mul_u32_u24 v11, 43691, v10
    v_lshrrev_b32 v11, 22, v11
    v_mul_u32_u24 v12, 96, v11
    v_xor_b32 v6, 32, v5
    buffer_load_dwordx4 v6, s[20:23], m0 offen lds
    s_add_u32 m0, m0, 1024
    v_sub_u32 v10, v10, v12
    v_lshl_add_u32 v11, s3, 2, v11
    v_xor_b32 v10, v10, v11
    v_mul_u32_u24 v11, 1536, v11
    v_lshl_add_u32 v29, v10, 4, v11
    v_xor_b32 v10, v8, v9
    v_mul_u32_u24 v11, 1536, v8
    v_add_u32 v11, 131072, v11
    v_xor_b32 v6, 48, v5
    buffer_load_dwordx4 v6, s[20:23], m0 offen lds
    s_add_u32 m0, m0, 1024
    v_xor_b32 v12, 0, v10
    v_lshl_add_u32 v30, v12, 4, v11
    v_xor_b32 v12, 4, v10
    v_lshl_add_u32 v31, v12, 4, v11
    v_xor_b32 v12, 8, v10
    v_lshl_add_u32 v32, v12, 4, v11
    v_xor_b32 v12, 12, v10
    v_lshl_add_u32 v33, v12, 4, v11
    v_xor_b32 v6, 64, v5
    buffer_load_dwordx4 v6, s[20:23], m0 offen lds
    s_add_u32 m0, m0, 1024
    s_lshr_b32 s45, s3, 1
    s_lshl_b32 s45, s45, 10
    s_and_b32 s46, s3, 1
    s_lshl_b32 s46, s46, 4
    s_add_u32 s45, s45, s46
    s_add_u32 s45, s45, 155648
    v_lshrrev_b32 v10, 2, v8
    v_lshlrev_b32 v11, 8, v10
    v_xor_b32 v6, 80, v5
    buffer_load_dwordx4 v6, s[20:23], m0 offen lds
    s_add_u32 m0, m0, 1024
    v_lshl_add_u32 v11, v9, 6, v11
    v_and_b32 v12, 3, v8
    v_lshl_add_u32 v11, v12, 2, v11
    v_add_u32 v34, s45, v11
    s_lshl_b32 s45, s3, 3
    s_add_u32 s45, s45, 157696
    v_lshl_add_u32 v35, v9, 5, s45
    v_add_u32 v36, 155648, v211
    v_xor_b32 v6, 96, v5
    buffer_load_dwordx4 v6, s[20:23], m0 offen lds
    s_add_u32 m0, m0, 1024
    v_lshlrev_b32 v37, 5, v9
    v_add_u32 v37, 157696, v37
    s_lshl_b32 s45, s3, 10
    s_add_u32 s45, s45, 158720
    v_lshl_add_u32 v11, v9, 8, s45
    v_lshl_add_u32 v11, v12, 4, v11
    v_add_u32 v39, 64, v11
    v_lshl_add_u32 v38, v10, 2, v11
    v_xor_b32 v6, 112, v5
    buffer_load_dwordx4 v6, s[20:23], m0 offen lds
    v_add_u32 v11, 72, v11
    v_cmp_eq_u32 vcc, 3, v10
    s_nop 1
    v_cndmask_b32 v38, v38, v11, vcc
    v_add_u32 v40, s45, v211
    v_mul_u32_u24 v41, 98304, v9
    v_lshl_add_u32 v41, v8, 4, v41
    v_mul_u32_u24 v42, 49152, v2
    v_lshl_add_u32 v42, v3, 4, v42
    s_add_u32 s43, s43, 1
    s_xor_b32 s40, s43, s38
    s_lshl_b32 s41, s40, 13
    s_add_u32 m0, s41, s42
    s_xor_b32 s41, s40, s3
    s_and_b32 s41, s41, 1
    s_lshl_b32 s41, s41, 1
    s_lshr_b32 s40, s40, 1
    s_or_b32 s41, s41, s40
    s_lshl_b32 s41, s41, 6
    v_xor_b32 v5, s41, v211
    buffer_load_dwordx4 v5, s[20:23], m0 offen lds
    s_add_u32 m0, m0, 1024
    s_mul_i32 s47, s38, 393216
    s_mul_i32 s45, s37, 1536
    s_add_u32 s47, s47, s45
    s_mul_i32 s45, s3, 384
    s_add_u32 s47, s47, s45
    s_add_u32 s47, s47, 1048576
    s_add_u32 s48, s47, 49152
Y_pg3:
    s_cbranch_execz LY_back
    s_mul_i32 s49, s38, 24576
    v_xor_b32 v6, 16, v5
    buffer_load_dwordx4 v6, s[20:23], m0 offen lds
    s_add_u32 m0, m0, 1024
    s_add_u32 s49, s49, 65536
    s_mul_i32 s50, s35, 0
    s_add_u32 s49, s49, s50
    s_mul_i32 s50, s3, 6144
    s_add_u32 s50, s50, 131072
    s_lshl_b32 s52, s38, 5
    s_add_u32 s52, s52, s37
    s_lshl_b32 s52, s52, 2
    v_xor_b32 v6, 32, v5
    buffer_load_dwordx4 v6, s[20:23], m0 offen lds
    s_add_u32 m0, m0, 1024
    s_add_u32 s52, s52, s3
    s_lshl_b32 s52, s52, 10
    s_add_u32 s52, s52, 3145728
    s_mov_b64 s[32:33], 0xffff
    s_lshl_b32 s45, s38, 4
    s_lshl_b64 s[32:33], s[32:33], s45
    v_mov_b32 v44, 0x3f803f80
    v_mov_b32 v45, v44
    v_xor_b32 v6, 48, v5
    buffer_load_dwordx4 v6, s[20:23], m0 offen lds
    s_add_u32 m0, m0, 1024
    v_mov_b32 v46, v44
    v_mov_b32 v47, v44
    s_mul_i32 s45, s35, 27
    s_lshr_b32 s58, s45, 3
    s_add_u32 s45, s45, 27
    s_lshr_b32 s45, s45, 3
    s_sub_u32 s57, s45, s58
    s_lshl_b32 s45, s55, 4
    v_xor_b32 v6, 64, v5
    buffer_load_dwordx4 v6, s[20:23], m0 offen lds
    s_add_u32 m0, m0, 1024
    s_add_u32 s45, s45, s39
    s_mul_i32 s46, s45, 10
    s_add_u32 s46, s46, 0
    v_lshrrev_b32 v10, 2, v0
    v_min_u32 v10, 9, v10
    v_add_u32 v10, s46, v10
    s_mul_i32 s45, s45, 10
    v_lshrrev_b32 v11, 5, v10
    v_xor_b32 v6, 80, v5
    buffer_load_dwordx4 v6, s[20:23], m0 offen lds
    s_add_u32 m0, m0, 1024
    v_and_b32 v10, 31, v10
    v_mad_u32_u24 v10, v10, 20, v11
    v_mul_u32_u24 v10, 3456, v10
    s_sub_u32 s59, s57, 1
    v_and_b32 v11, 3, v0
    v_min_u32 v11, s59, v11
    v_lshl_add_u32 v216, v11, 7, v10
    s_mul_i32 s45, s45, s57
    v_xor_b32 v6, 96, v5
    buffer_load_dwordx4 v6, s[20:23], m0 offen lds
    s_add_u32 m0, m0, 1024
    s_mul_i32 s59, s57, 10
    s_sub_u32 s59, s59, 1
    v_min_u32 v10, s59, v0
    v_add_u32 v10, s45, v10
    v_lshlrev_b32 v217, 7, v10
    s_mul_i32 s59, s58, 81920
    s_lshl_b32 s58, s58, 7
    s_mov_b32 s57, 0
    v_xor_b32 v6, 112, v5
    buffer_load_dwordx4 v6, s[20:23], m0 offen lds
    s_lshr_b32 s45, s38, 1
    v_bfe_u32 v10, v0, 2, 1
    v_xor_b32 v10, s45, v10
    v_bfe_u32 v12, v0, 3, 1
    v_lshlrev_b32 v11, 1, v9
    v_lshl_add_u32 v11, v10, 4, v11
    v_lshl_add_u32 v11, v12, 5, v11
    v_lshlrev_b32 v11, 10, v11
    s_add_u32 s43, s43, 1
    s_xor_b32 s40, s43, s38
    s_lshl_b32 s41, s40, 13
    s_add_u32 m0, s41, s42
    s_xor_b32 s41, s40, s3
    s_and_b32 s41, s41, 1
    s_lshl_b32 s41, s41, 1
    s_lshr_b32 s40, s40, 1
    s_or_b32 s41, s41, s40
    s_lshl_b32 s41, s41, 6
    v_xor_b32 v5, s41, v211
    buffer_load_dwordx4 v5, s[20:23], m0 offen lds
    s_add_u32 m0, m0, 1024
    v_and_b32 v13, 1, v0
    v_lshl_add_u32 v11, v13, 3, v11
    v_lshl_add_u32 v11, s3, 8, v11
    v_lshlrev_b32 v10, 1, v10
    v_xor_b32 v10, v10, v9
    v_lshl_or_b32 v10, v12, 2, v10
    v_lshlrev_b32 v10, 1, v10
    v_bfe_u32 v13, v0, 1, 1
    v_xor_b32 v6, 16, v5
    buffer_load_dwordx4 v6, s[20:23], m0 offen lds
    s_add_u32 m0, m0, 1024
    v_or_b32 v10, v10, v13
    v_lshl_add_u32 v13, v10, 4, v11
    v_xor_b32 v176, 0, v13
    v_xor_b32 v177, 16, v13
    v_xor_b32 v178, 65536, v13
    v_xor_b32 v179, 65552, v13
    v_xor_b32 v180, 32, v13
    v_xor_b32 v181, 48, v13
    v_xor_b32 v6, 32, v5
    buffer_load_dwordx4 v6, s[20:23], m0 offen lds
    s_add_u32 m0, m0, 1024
    v_xor_b32 v182, 65568, v13
    v_xor_b32 v183, 65584, v13
    v_xor_b32 v184, 64, v13
    v_xor_b32 v185, 80, v13
    v_xor_b32 v186, 65600, v13
    v_xor_b32 v187, 65616, v13
    v_xor_b32 v188, 96, v13
    v_xor_b32 v189, 112, v13
    v_xor_b32 v6, 48, v5
    buffer_load_dwordx4 v6, s[20:23], m0 offen lds
    s_add_u32 m0, m0, 1024
    v_xor_b32 v190, 65632, v13
    v_xor_b32 v191, 65648, v13
    v_xor_b32 v192, 128, v13
    v_xor_b32 v193, 144, v13
    v_xor_b32 v194, 65664, v13
    v_xor_b32 v195, 65680, v13
    v_xor_b32 v196, 160, v13
    v_xor_b32 v197, 176, v13
    v_xor_b32 v6, 64, v5
    buffer_load_dwordx4 v6, s[20:23], m0 offen lds
    s_add_u32 m0, m0, 1024
    v_xor_b32 v198, 65696, v13
    v_xor_b32 v199, 65712, v13
    v_xor_b32 v200, 192, v13
    v_xor_b32 v201, 208, v13
    v_xor_b32 v202, 65728, v13
    v_xor_b32 v203, 65744, v13
    v_xor_b32 v204, 224, v13
    v_xor_b32 v205, 240, v13
    v_xor_b32 v6, 80, v5
    buffer_load_dwordx4 v6, s[20:23], m0 offen lds
    s_add_u32 m0, m0, 1024
    v_xor_b32 v206, 65760, v13
    v_xor_b32 v207, 65776, v13
    v_and_b32 v10, 1, v0
    v_mul_u32_u24 v10, 0xaaaa, v10
    v_add_u32 v13, 0x4444, v10
    s_lshl_b32 s45, s38, 7
    s_lshl_b32 s56, s3, 5
    s_add_u32 s45, s45, s56
    v_xor_b32 v6, 96, v5
    buffer_load_dwordx4 v6, s[20:23], m0 offen lds
    s_add_u32 m0, m0, 1024
    s_lshr_b32 s56, s39, 2
    s_lshl_b32 s56, s56, 3
    s_add_u32 s45, s45, s56
    v_add_u32 v10, s45, v2
    v_lshlrev_b32 v10, 13, v10
    v_lshl_or_b32 v218, v3, 7, v10
    s_lshl_b32 s56, s35, 10
    s_mov_b32 s51, 200000
    v_xor_b32 v6, 112, v5
    buffer_load_dwordx4 v6, s[20:23], m0 offen lds
    s_mov_b32 s53, 0x3fb8aa3b
    s_nop 0
    s_nop 0
    s_nop 0
L_phY:
    s_mov_b32 m0, s50
    s_waitcnt vmcnt(16)
    s_cmp_eq_u32 s55, 0
    s_cbranch_scc0 LY_np0
    buffer_load_dword v14, v43, s[4:7], s54 offen sc1
LY_np0:
    ds_read_b128 a[0:3], v16 offset:0
    ds_read_b128 a[4:7], v17 offset:0
    ds_read_b128 a[8:11], v18 offset:0
    ds_read_b128 a[12:15], v19 offset:0
    ds_read_b128 a[16:19], v16 offset:256
    ds_read_b128 a[20:23], v17 offset:256
    ds_read_b128 a[24:27], v18 offset:256
    ds_read_b128 a[28:31], v19 offset:256
    ds_read_b128 a[32:35], v16 offset:512
    ds_read_b128 a[36:39], v17 offset:512
    ds_read_b128 a[40:43], v18 offset:512
    ds_read_b128 a[44:47], v19 offset:512
    ds_read_b128 a[48:51], v16 offset:768
    ds_read_b128 a[52:55], v17 offset:768
    ds_read_b128 a[56:59], v18 offset:768
    ds_read_b128 a[60:63], v19 offset:768
    s_cbranch_scc0 LY_w123
    s_waitcnt vmcnt(1)
    s_branch LY_qkr
LY_w123:
    s_waitcnt vmcnt(0)
LY_qkr:
    s_cbranch_scc0 LY_wait
    s_waitcnt vmcnt(0)
    v_cmp_ne_u32 vcc, s34, v14
    s_cbranch_vccz LY_wait
    s_mov_b32 s45, 200000
LY_poll:
    buffer_load_dword v14, v43, s[4:7], s54 offen sc1
    s_sub_u32 s45, s45, 1
    s_cbranch_scc1 LY_poll_d
    s_waitcnt vmcnt(0)
    v_cmp_ne_u32 vcc, s34, v14
    s_cbranch_vccnz LY_poll
LY_poll_d:
LY_wait:
    s_barrier
    buffer_load_dwordx4 v24, s[4:7], s49 offen sc1 lds
    s_add_u32 m0, m0, 1024
    s_nop 0
    buffer_load_dwordx4 v25, s[4:7], s49 offen sc1 lds
    s_add_u32 m0, m0, 1024
    s_nop 0
    buffer_load_dwordx4 v26, s[4:7], s49 offen sc1 lds
    s_add_u32 m0, m0, 1024
    s_nop 0
    buffer_load_dwordx4 v27, s[4:7], s49 offen sc1 lds
    s_add_u32 m0, m0, 1024
    s_nop 0
    buffer_load_dwordx4 v28, s[4:7], s49 offen sc1 lds
    s_add_u32 m0, m0, 1024
    s_nop 0
    buffer_load_dwordx4 v29, s[4:7], s49 offen sc1 lds
    ds_read_b128 a[64:67], v20 offset:0
    ds_read_b128 a[68:71], v21 offset:0
    ds_read_b128 a[72:75], v22 offset:0
    ds_read_b128 a[76:79], v23 offset:0
    ds_read_b128 a[80:83], v20 offset:256
    ds_read_b128 a[84:87], v21 offset:256
    ds_read_b128 a[88:91], v22 offset:256
    ds_read_b128 a[92:95], v23 offset:256
    ds_read_b128 a[96:99], v20 offset:512
    ds_read_b128 a[100:103], v21 offset:512
    ds_read_b128 a[104:107], v22 offset:512
    ds_read_b128 a[108:111], v23 offset:512
    ds_read_b128 a[112:115], v20 offset:768
    ds_read_b128 a[116:119], v21 offset:768
    ds_read_b128 a[120:123], v22 offset:768
    ds_read_b128 a[124:127], v23 offset:768
    ds_read_b64_tr_b16 a[224:225], v200 offset:0
    ds_read_b64_tr_b16 a[226:227], v201 offset:1024
    ds_read_b64_tr_b16 a[228:229], v184 offset:8192
    ds_read_b64_tr_b16 a[230:231], v185 offset:9216
    ds_read_b64_tr_b16 a[232:233], v202 offset:0
    ds_read_b64_tr_b16 a[234:235], v203 offset:1024
    ds_read_b64_tr_b16 a[236:237], v186 offset:8192
    ds_read_b64_tr_b16 a[238:239], v187 offset:9216
    ds_read_b64_tr_b16 a[240:241], v204 offset:0
    ds_read_b64_tr_b16 a[242:243], v205 offset:1024
    ds_read_b64_tr_b16 a[244:245], v188 offset:8192
    ds_read_b64_tr_b16 a[246:247], v189 offset:9216
    ds_read_b64_tr_b16 a[248:249], v206 offset:0
    ds_read_b64_tr_b16 a[250:251], v207 offset:1024
    ds_read_b64_tr_b16 a[252:253], v190 offset:8192
    ds_read_b64_tr_b16 a[254:255], v191 offset:9216
    ds_read_b64_tr_b16 a[128:129], v176 offset:0
    ds_read_b64_tr_b16 a[130:131], v177 offset:1024
    ds_read_b64_tr_b16 a[132:133], v192 offset:8192
    ds_read_b64_tr_b16 a[134:135], v193 offset:9216
    ds_read_b64_tr_b16 a[136:137], v178 offset:0
    ds_read_b64_tr_b16 a[138:139], v179 offset:1024
    ds_read_b64_tr_b16 a[140:141], v194 offset:8192
    ds_read_b64_tr_b16 a[142:143], v195 offset:9216
    ds_read_b64_tr_b16 a[144:145], v180 offset:0
    ds_read_b64_tr_b16 a[146:147], v181 offset:1024
    ds_read_b64_tr_b16 a[148:149], v196 offset:8192
    ds_read_b64_tr_b16 a[150:151], v197 offset:9216
    ds_read_b64_tr_b16 a[152:153], v182 offset:0
    ds_read_b64_tr_b16 a[154:155], v183 offset:1024
    ds_read_b64_tr_b16 a[156:157], v198 offset:8192
    ds_read_b64_tr_b16 a[158:159], v199 offset:9216
    ds_read_b64_tr_b16 a[160:161], v184 offset:0
    ds_read_b64_tr_b16 a[162:163], v185 offset:1024
    ds_read_b64_tr_b16 a[164:165], v200 offset:8192
    ds_read_b64_tr_b16 a[166:167], v201 offset:9216
    ds_read_b64_tr_b16 a[168:169], v186 offset:0
    ds_read_b64_tr_b16 a[170:171], v187 offset:1024
    ds_read_b64_tr_b16 a[172:173], v202 offset:8192
    ds_read_b64_tr_b16 a[174:175], v203 offset:9216
    ds_read_b64_tr_b16 a[176:177], v188 offset:0
    ds_read_b64_tr_b16 a[178:179], v189 offset:1024
    ds_read_b64_tr_b16 a[180:181], v204 offset:8192
    ds_read_b64_tr_b16 a[182:183], v205 offset:9216
    ds_read_b64_tr_b16 a[184:185], v190 offset:0
    ds_read_b64_tr_b16 a[186:187], v191 offset:1024
    ds_read_b64_tr_b16 a[188:189], v206 offset:8192
    ds_read_b64_tr_b16 a[190:191], v207 offset:9216
    s_mov_b32 exec_hi, 0xff
    buffer_load_dword v250, v217, s[16:19], s59 offen
    s_mov_b32 exec_hi, -1
    s_mov_b32 exec_hi, 0xff
    buffer_load_dword v250, v216, s[12:15], s58 offen
    s_mov_b32 exec_hi, -1
    ds_read_b64_tr_b16 a[192:193], v192 offset:0
    ds_read_b64_tr_b16 a[194:195], v193 offset:1024
    ds_read_b64_tr_b16 a[196:197], v176 offset:8192
    ds_read_b64_tr_b16 a[198:199], v177 offset:9216
    ds_read_b64_tr_b16 a[200:201], v194 offset:0
    ds_read_b64_tr_b16 a[202:203], v195 offset:1024
    ds_read_b64_tr_b16 a[204:205], v178 offset:8192
    ds_read_b64_tr_b16 a[206:207], v179 offset:9216
    ds_read_b64_tr_b16 a[208:209], v196 offset:0
    ds_read_b64_tr_b16 a[210:211], v197 offset:1024
    ds_read_b64_tr_b16 a[212:213], v180 offset:8192
    ds_read_b64_tr_b16 a[214:215], v181 offset:9216
    ds_read_b64_tr_b16 a[216:217], v198 offset:0
    ds_read_b64_tr_b16 a[218:219], v199 offset:1024
    ds_read_b64_tr_b16 a[220:221], v182 offset:8192
    ds_read_b64_tr_b16 a[222:223], v183 offset:9216
    v_mov_b32 v176, 0
    v_mov_b32 v177, 0
    v_mov_b32 v178, 0
    v_mov_b32 v179, 0
    v_mov_b32 v180, 0
    v_mov_b32 v181, 0
    v_mov_b32 v182, 0
    v_mov_b32 v183, 0
    v_mov_b32 v184, 0
    v_mov_b32 v185, 0
    v_mov_b32 v186, 0
    v_mov_b32 v187, 0
    v_mov_b32 v188, 0
    v_mov_b32 v189, 0
    v_mov_b32 v190, 0
    v_mov_b32 v191, 0
    v_mov_b32 v192, 0
    v_mov_b32 v193, 0
    v_mov_b32 v194, 0
    v_mov_b32 v195, 0
    v_mov_b32 v196, 0
    v_mov_b32 v197, 0
    v_mov_b32 v198, 0
    v_mov_b32 v199, 0
    v_mov_b32 v200, 0
    v_mov_b32 v201, 0
    v_mov_b32 v202, 0
    v_mov_b32 v203, 0
    v_mov_b32 v204, 0
    v_mov_b32 v205, 0
    v_mov_b32 v206, 0
    v_mov_b32 v207, 0
    s_waitcnt vmcnt(2) lgkmcnt(0)
LY_retry:
    s_barrier
    ds_read_b128 v[64:67], v30 offset:256
    ds_read_b128 v[48:51], v30 offset:0
    ds_read_b128 v[52:55], v31 offset:0
    ds_read_b128 v[68:71], v31 offset:256
    ds_read_b128 v[56:59], v32 offset:0
    ds_read_b128 v[60:63], v33 offset:0
    s_waitcnt lgkmcnt(4)
    v_xor_b32 v15, v51, v212
    v_mov_b32 v51, v64
    ds_read_b128 v[88:91], v32 offset:512
    s_waitcnt lgkmcnt(4)
    v_bitop3_b32 v15, v15, v55, v212 bitop3:0xf6
    v_mov_b32 v55, v65
    v_mfma_f32_16x16x32_bf16 v[144:147], v[48:51], a[0:3], 0
    ds_read_b128 v[72:75], v32 offset:256
    ds_read_b128 v[76:79], v33 offset:256
    v_mfma_f32_16x16x32_bf16 v[148:151], v[48:51], a[64:67], 0
    s_waitcnt lgkmcnt(4)
    v_bitop3_b32 v15, v15, v59, v212 bitop3:0xf6
    v_mov_b32 v59, v66
    v_mfma_f32_16x16x32_bf16 v[144:147], v[52:55], a[4:7], v[144:147]
    ds_read_b128 v[92:95], v33 offset:512
    ds_read_b128 v[80:83], v30 offset:512
    v_mfma_f32_16x16x32_bf16 v[148:151], v[52:55], a[68:71], v[148:151]
    s_waitcnt lgkmcnt(5)
    v_bitop3_b32 v15, v15, v63, v212 bitop3:0xf6
    v_mov_b32 v63, v70
    v_mfma_f32_16x16x32_bf16 v[144:147], v[56:59], a[8:11], v[144:147]
    ds_read_b128 v[84:87], v31 offset:512
    v_bitop3_b32 v15, v15, v67, v212 bitop3:0xf6
    v_mfma_f32_16x16x32_bf16 v[148:151], v[56:59], a[72:75], v[148:151]
    s_waitcnt lgkmcnt(4)
    v_bitop3_b32 v15, v15, v75, v212 bitop3:0xf6
    v_mov_b32 v75, v88
    v_mfma_f32_16x16x32_bf16 v[144:147], v[60:63], a[12:15], v[144:147]
    s_waitcnt lgkmcnt(3)
    v_bitop3_b32 v15, v15, v79, v212 bitop3:0xf6
    v_mov_b32 v79, v89
    v_mfma_f32_16x16x32_bf16 v[148:151], v[60:63], a[76:79], v[148:151]
    ds_read_b128 v[112:115], v30 offset:1024
    v_bitop3_b32 v15, v15, v71, v212 bitop3:0xf6
    v_mfma_f32_16x16x32_bf16 v[144:147], v[72:75], a[16:19], v[144:147]
    ds_read_b128 v[96:99], v30 offset:768
    ds_read_b128 v[100:103], v31 offset:768
    v_mfma_f32_16x16x32_bf16 v[148:151], v[72:75], a[80:83], v[148:151]
    s_waitcnt lgkmcnt(3)
    v_bitop3_b32 v15, v15, v83, v212 bitop3:0xf6
    v_mov_b32 v83, v90
    v_mfma_f32_16x16x32_bf16 v[144:147], v[76:79], a[20:23], v[144:147]
    ds_read_b128 v[116:119], v31 offset:1024
    ds_read_b128 v[104:107], v32 offset:768
    v_mfma_f32_16x16x32_bf16 v[148:151], v[76:79], a[84:87], v[148:151]
    v_bitop3_b32 v15, v15, v87, v212 bitop3:0xf6
    v_mov_b32 v87, v94
    v_mfma_f32_16x16x32_bf16 v[144:147], v[80:83], a[24:27], v[144:147]
    ds_read_b128 v[108:111], v33 offset:768
    v_bitop3_b32 v15, v15, v91, v212 bitop3:0xf6
    v_mfma_f32_16x16x32_bf16 v[148:151], v[80:83], a[88:91], v[148:151]
    s_waitcnt lgkmcnt(4)
    v_bitop3_b32 v15, v15, v99, v212 bitop3:0xf6
    v_mov_b32 v99, v112
    v_mfma_f32_16x16x32_bf16 v[144:147], v[84:87], a[28:31], v[144:147]
    s_waitcnt lgkmcnt(3)
    v_bitop3_b32 v15, v15, v103, v212 bitop3:0xf6
    v_mov_b32 v103, v113
    v_mfma_f32_16x16x32_bf16 v[148:151], v[84:87], a[92:95], v[148:151]
    ds_read_b128 v[136:139], v32 offset:1280
    v_bitop3_b32 v15, v15, v95, v212 bitop3:0xf6
    v_mfma_f32_16x16x32_bf16 v[144:147], v[96:99], a[32:35], v[144:147]
    ds_read_b128 v[120:123], v32 offset:1024
    ds_read_b128 v[124:127], v33 offset:1024
    v_mfma_f32_16x16x32_bf16 v[148:151], v[96:99], a[96:99], v[148:151]
    s_waitcnt lgkmcnt(3)
    v_bitop3_b32 v15, v15, v107, v212 bitop3:0xf6
    v_mov_b32 v107, v114
    v_mfma_f32_16x16x32_bf16 v[144:147], v[100:103], a[36:39], v[144:147]
    ds_read_b128 v[140:143], v33 offset:1280
    ds_read_b128 v[128:131], v30 offset:1280
    v_mfma_f32_16x16x32_bf16 v[148:151], v[100:103], a[100:103], v[148:151]
    v_bitop3_b32 v15, v15, v111, v212 bitop3:0xf6
    v_mov_b32 v111, v118
    v_mfma_f32_16x16x32_bf16 v[144:147], v[104:107], a[40:43], v[144:147]
    ds_read_b128 v[132:135], v31 offset:1280
    v_bitop3_b32 v15, v15, v115, v212 bitop3:0xf6
    v_mfma_f32_16x16x32_bf16 v[148:151], v[104:107], a[104:107], v[148:151]
    s_waitcnt lgkmcnt(4)
    v_bitop3_b32 v15, v15, v123, v212 bitop3:0xf6
    v_mov_b32 v123, v136
    v_mfma_f32_16x16x32_bf16 v[144:147], v[108:111], a[44:47], v[144:147]
    s_waitcnt lgkmcnt(3)
    v_bitop3_b32 v15, v15, v127, v212 bitop3:0xf6
    v_mov_b32 v127, v137
    v_mfma_f32_16x16x32_bf16 v[148:151], v[108:111], a[108:111], v[148:151]
    v_bitop3_b32 v15, v15, v119, v212 bitop3:0xf6
    v_mfma_f32_16x16x32_bf16 v[144:147], v[120:123], a[48:51], v[144:147]
    v_bitop3_b32 v15, v15, v139, v212 bitop3:0xf6
    v_mfma_f32_16x16x32_bf16 v[148:151], v[120:123], a[112:115], v[148:151]
    s_waitcnt lgkmcnt(0)
    v_bitop3_b32 v15, v15, v131, v212 bitop3:0xf6
    v_mov_b32 v131, v138
    v_mfma_f32_16x16x32_bf16 v[144:147], v[124:127], a[52:55], v[144:147]
    v_bitop3_b32 v15, v15, v135, v212 bitop3:0xf6
    v_mov_b32 v135, v142
    v_mfma_f32_16x16x32_bf16 v[144:147], v[128:131], a[56:59], v[144:147]
    v_bitop3_b32 v15, v15, v143, v212 bitop3:0xf6
    v_mfma_f32_16x16x32_bf16 v[144:147], v[132:135], a[60:63], v[144:147]
    v_cmp_ne_u32 vcc, 0, v15
    v_mfma_f32_16x16x32_bf16 v[148:151], v[124:127], a[116:119], v[148:151]
    s_cbranch_vccnz LY_bad
LY_ok:
    v_mfma_f32_16x16x32_bf16 v[148:151], v[128:131], a[120:123], v[148:151]
    v_mfma_f32_16x16x32_bf16 v[148:151], v[132:135], a[124:127], v[148:151]
    s_nop 2
    v_add_f32 v144, v144, v145
    v_add_f32 v146, v146, v147
    v_cvt_pk_bf16_f32 v145, v144, v146
    v_lshlrev_b32 v144, 16, v145
    v_and_b32 v146, 0xffff0000, v145
    v_mul_f32 v144, 0x3db504f3, v144
    v_mul_f32 v146, 0x3db504f3, v146
    v_cvt_pk_bf16_f32 v145, v144, v146
    v_lshlrev_b32 v144, 16, v145
    v_and_b32 v146, 0xffff0000, v145
    v_add_f32 v148, v148, v149
    v_add_f32 v150, v150, v151
    v_cvt_pk_bf16_f32 v149, v148, v150
    v_lshlrev_b32 v148, 16, v149
    v_and_b32 v150, 0xffff0000, v149
    v_mul_f32 v148, 0x3db504f3, v148
    v_mul_f32 v150, 0x3db504f3, v150
    v_cvt_pk_bf16_f32 v149, v148, v150
    v_lshlrev_b32 v148, 16, v149
    v_and_b32 v150, 0xffff0000, v149
    v_max_f32 v152, v144, v148
    v_max_f32 v153, v146, v150
    s_nop 0
    v_max_f32_dpp v152, v152, v152 quad_perm:[1,0,3,2] row_mask:0xf bank_mask:0xf
    v_max_f32_dpp v153, v153, v153 quad_perm:[1,0,3,2] row_mask:0xf bank_mask:0xf
    s_nop 0
    v_max_f32_dpp v152, v152, v152 quad_perm:[2,3,0,1] row_mask:0xf bank_mask:0xf
    v_max_f32_dpp v153, v153, v153 quad_perm:[2,3,0,1] row_mask:0xf bank_mask:0xf
    s_nop 0
    v_max_f32_dpp v152, v152, v152 row_half_mirror row_mask:0xf bank_mask:0xf
    v_max_f32_dpp v153, v153, v153 row_half_mirror row_mask:0xf bank_mask:0xf
    s_nop 0
    v_max_f32_dpp v152, v152, v152 row_mirror row_mask:0xf bank_mask:0xf
    v_max_f32_dpp v153, v153, v153 row_mirror row_mask:0xf bank_mask:0xf
    ds_write_b64 v35, v[152:153]
    s_waitcnt lgkmcnt(0)
    s_barrier
    ds_read_b128 v[56:59], v37
    ds_read_b128 v[60:63], v37 offset:16
    s_cmp_eq_u32 s3, 3
    s_cbranch_scc0 L_nf3
    s_mov_b64 exec, s[32:33]
    buffer_store_dwordx4 v[212:215], v211, s[4:7], s52 offen sc1
    s_mov_b64 exec, -1
L_nf3:
    s_waitcnt lgkmcnt(1)
    v_max_f32 v64, v56, v58
    v_max_f32 v66, v57, v59
    s_waitcnt lgkmcnt(0)
    v_max3_f32 v64, v64, v60, v62
    v_max3_f32 v66, v66, v61, v63
    v_mul_f32 v64, s53, v64
    v_mul_f32 v66, s53, v66
    v_fma_f32 v144, v144, s53, -v64
    v_fma_f32 v148, v148, s53, -v64
    v_fma_f32 v146, v146, s53, -v66
    v_fma_f32 v150, v150, s53, -v66
    v_exp_f32 v144, v144
    v_exp_f32 v148, v148
    v_exp_f32 v146, v146
    v_exp_f32 v150, v150
    v_cvt_pk_bf16_f32 v144, v144, v148
    ds_write_b32 v34, v144
    v_cvt_pk_bf16_f32 v146, v146, v150
    ds_write_b32 v34, v146 offset:32
    s_waitcnt lgkmcnt(0)
    s_barrier
    ds_read_b128 v[48:51], v36
    ds_read_b128 v[52:55], v36 offset:1024
    v_mov_b32 v163, v212
    v_mov_b32 v167, v212
    s_waitcnt lgkmcnt(1)
    v_mfma_f32_16x16x32_bf16 v[68:71], v[48:51], v[44:47], 0
    v_smfmac_f32_16x16x64_bf16 v[200:203], v[48:51], a[224:231], v13
    v_smfmac_f32_16x16x64_bf16 v[204:207], v[48:51], a[240:247], v13
    s_waitcnt lgkmcnt(0)
    v_mfma_f32_16x16x32_bf16 v[68:71], v[52:55], v[44:47], v[68:71]
    v_smfmac_f32_16x16x64_bf16 v[200:203], v[52:55], a[232:239], v13
    v_smfmac_f32_16x16x64_bf16 v[204:207], v[52:55], a[248:255], v13
    v_smfmac_f32_16x16x64_bf16 v[176:179], v[48:51], a[128:135], v13
    v_smfmac_f32_16x16x64_bf16 v[180:183], v[48:51], a[144:151], v13
    v_smfmac_f32_16x16x64_bf16 v[184:187], v[48:51], a[160:167], v13
    v_smfmac_f32_16x16x64_bf16 v[188:191], v[48:51], a[176:183], v13
    v_smfmac_f32_16x16x64_bf16 v[192:195], v[48:51], a[192:199], v13
    v_smfmac_f32_16x16x64_bf16 v[196:199], v[48:51], a[208:215], v13
    v_add_f32 v65, v68, v69
    v_add_f32 v67, v70, v71
    ds_write_b64 v39, v[64:65]
    v_add_f32 v200, v200, v201
    v_add_f32 v202, v202, v203
    ds_write_b64 v39, v[66:67] offset:128
    v_add_f32 v204, v204, v205
    v_add_f32 v206, v206, v207
    v_smfmac_f32_16x16x64_bf16 v[176:179], v[52:55], a[136:143], v13
    v_cvt_pk_bf16_f32 v76, v200, v204
    v_cvt_pk_bf16_f32 v77, v202, v206
    ds_write_b32 v38, v76
    ds_write_b32 v38, v77 offset:128
    v_smfmac_f32_16x16x64_bf16 v[180:183], v[52:55], a[152:159], v13
    v_smfmac_f32_16x16x64_bf16 v[184:187], v[52:55], a[168:175], v13
    s_waitcnt lgkmcnt(0)
    ds_read_b128 v[168:171], v40
    v_smfmac_f32_16x16x64_bf16 v[188:191], v[52:55], a[184:191], v13
    v_smfmac_f32_16x16x64_bf16 v[192:195], v[52:55], a[200:207], v13
    v_smfmac_f32_16x16x64_bf16 v[196:199], v[52:55], a[216:223], v13
    v_add_f32 v176, v176, v177
    v_add_f32 v178, v178, v179
    v_add_f32 v180, v180, v181
    v_add_f32 v182, v182, v183
    v_cvt_pk_bf16_f32 v160, v176, v180
    v_cvt_pk_bf16_f32 v164, v178, v182
    v_add_f32 v184, v184, v185
    v_add_f32 v186, v186, v187
    v_add_f32 v188, v188, v189
    v_add_f32 v190, v190, v191
    v_cvt_pk_bf16_f32 v161, v184, v188
    v_cvt_pk_bf16_f32 v165, v186, v190
    s_waitcnt lgkmcnt(0)
    v_mov_b32 v171, v212
    buffer_store_dwordx4 v[168:171], v42, s[4:7], s47 offen offset:256 sc1
    v_add_f32 v192, v192, v193
    v_add_f32 v194, v194, v195
    v_add_f32 v196, v196, v197
    v_add_f32 v198, v198, v199
    v_cvt_pk_bf16_f32 v162, v192, v196
    v_cvt_pk_bf16_f32 v166, v194, v198
    buffer_store_dwordx4 v[160:163], v41, s[4:7], s47 offen sc1
    buffer_store_dwordx4 v[164:167], v41, s[4:7], s48 offen sc1
    s_mov_b32 s3, s55
    s_lshr_b32 s40, s37, 2
    s_and_b32 s41, s37, 3
    s_lshl_b32 s41, s41, 3
    s_add_u32 s40, s40, s41
    s_or_b32 s45, s38, s3
    s_cmp_eq_u32 s45, 0
    s_cbranch_scc0 L_fin
    s_cmp_ge_u32 s40, 20
    s_cbranch_scc1 L_fin
L_phF:
    v_and_b32 v4, 31, v0
    v_lshlrev_b32 v4, 1, v4
    s_lshl_b32 s41, s40, 6
    buffer_load_ushort v5, v4, s[8:11], s41 offen
    buffer_load_ushort v6, v4, s[24:27], s41 offen
    v_mul_u32_u24 v7, 2560, v2
    v_lshl_add_u32 v7, v3, 4, v7
    v_lshlrev_b32 v8, 12, v0
    v_lshlrev_b32 v216, 2, v0
    v_and_b32 v213, 0xff, v212
    v_bfe_u32 v214, v212, 8, 8
    s_lshl_b32 s42, s40, 7
    s_add_u32 s43, s42, 524288
    s_add_u32 s42, s42, 262144
    s_mov_b32 s46, 3017728
    s_lshl_b32 s45, s35, 7
    s_add_u32 s46, s46, s45
    v_min_u32 v9, 53, v0
    v_lshlrev_b32 v9, 12, v9
    s_mov_b32 s44, 3673088
    s_mov_b32 s51, 200000
    s_mov_b32 s50, 200000
    s_lshl_b32 s45, s35, 7
    s_add_u32 s44, s44, s45
LF_op:
    buffer_load_dword v13, v8, s[4:7], s46 offen sc1
    s_mov_b32 s45, s43
    buffer_load_dwordx4 v[16:19], v7, s[4:7], s45 offen sc1
    s_add_u32 s45, s45, 20480
    buffer_load_dwordx4 v[20:23], v7, s[4:7], s45 offen sc1
    s_add_u32 s45, s45, 20480
    buffer_load_dwordx4 v[24:27], v7, s[4:7], s45 offen sc1
    s_add_u32 s45, s45, 20480
    buffer_load_dwordx4 v[28:31], v7, s[4:7], s45 offen sc1
    s_add_u32 s45, s45, 20480
    buffer_load_dwordx4 v[32:35], v7, s[4:7], s45 offen sc1
    s_add_u32 s45, s45, 20480
    buffer_load_dwordx4 v[36:39], v7, s[4:7], s45 offen sc1
    s_add_u32 s45, s45, 20480
    v_mov_b32 v40, v213
    v_mov_b32 v41, v214
    v_mov_b32 v42, 0
    v_mov_b32 v43, 0
    s_mov_b32 exec_hi, 65535
    buffer_load_dwordx4 v[40:43], v7, s[4:7], s45 offen sc1
    s_mov_b64 exec, -1
    s_waitcnt vmcnt(7)
    v_cmp_ne_u32 s[56:57], s34, v13
    s_waitcnt vmcnt(6)
    v_xor_b32 v15, v16, v212
    s_waitcnt vmcnt(5)
    v_bitop3_b32 v15, v15, v20, v212 bitop3:0xf6
    s_waitcnt vmcnt(4)
    v_bitop3_b32 v15, v15, v24, v212 bitop3:0xf6
    s_waitcnt vmcnt(3)
Y_pg4:
    s_cbranch_execz LY_back
    v_bitop3_b32 v15, v15, v28, v212 bitop3:0xf6
    s_waitcnt vmcnt(2)
    v_bitop3_b32 v15, v15, v32, v212 bitop3:0xf6
    s_waitcnt vmcnt(1)
    v_bitop3_b32 v15, v15, v36, v212 bitop3:0xf6
    s_waitcnt vmcnt(0)
    v_bitop3_b32 v15, v15, v40, v212 bitop3:0xf6
    v_and_b32 v15, 0xff, v15
    v_cmp_ne_u32 vcc, 0, v15
    s_cmp_eq_u64 s[56:57], 0
    s_cbranch_scc1 LF_efok
    s_sub_u32 s50, s50, 1
    s_cbranch_scc1 LF_seq
    s_cbranch_vccnz LF_op
LF_seq:
    buffer_load_dword v13, v8, s[4:7], s46 offen sc1
    s_mov_b32 s49, 0
    s_branch LF_osum
LF_efok:
    s_mov_b32 s45, s42
    buffer_load_dwordx4 v[64:67], v7, s[4:7], s45 offen sc1
    s_add_u32 s45, s45, 20480
    buffer_load_dwordx4 v[68:71], v7, s[4:7], s45 offen sc1
    s_add_u32 s45, s45, 20480
    buffer_load_dwordx4 v[72:75], v7, s[4:7], s45 offen sc1
    s_add_u32 s45, s45, 20480
    buffer_load_dwordx4 v[76:79], v7, s[4:7], s45 offen sc1
    s_add_u32 s45, s45, 20480
    buffer_load_dwordx4 v[80:83], v7, s[4:7], s45 offen sc1
    s_add_u32 s45, s45, 20480
    buffer_load_dwordx4 v[84:87], v7, s[4:7], s45 offen sc1
    s_add_u32 s45, s45, 20480
    buffer_load_dwordx4 v[88:91], v7, s[4:7], s45 offen sc1
    s_add_u32 s45, s45, 20480
    buffer_load_dwordx4 v[92:95], v7, s[4:7], s45 offen sc1
    s_mov_b32 s49, 1
    s_cbranch_vccz LF_osum
LF_ob:
    s_mov_b32 s45, s43
    buffer_load_dwordx4 v[16:19], v7, s[4:7], s45 offen sc1
    s_add_u32 s45, s45, 20480
    buffer_load_dwordx4 v[20:23], v7, s[4:7], s45 offen sc1
    s_add_u32 s45, s45, 20480
    buffer_load_dwordx4 v[24:27], v7, s[4:7], s45 offen sc1
    s_add_u32 s45, s45, 20480
    buffer_load_dwordx4 v[28:31], v7, s[4:7], s45 offen sc1
    s_add_u32 s45, s45, 20480
    buffer_load_dwordx4 v[32:35], v7, s[4:7], s45 offen sc1
    s_add_u32 s45, s45, 20480
    buffer_load_dwordx4 v[36:39], v7, s[4:7], s45 offen sc1
    s_add_u32 s45, s45, 20480
    v_mov_b32 v40, v213
    v_mov_b32 v41, v214
    v_mov_b32 v42, 0
    v_mov_b32 v43, 0
    s_mov_b32 exec_hi, 65535
    buffer_load_dwordx4 v[40:43], v7, s[4:7], s45 offen sc1
    s_mov_b64 exec, -1
    s_waitcnt vmcnt(6)
    v_xor_b32 v15, v16, v212
    s_waitcnt vmcnt(5)
    v_bitop3_b32 v15, v15, v20, v212 bitop3:0xf6
    s_waitcnt vmcnt(4)
    v_bitop3_b32 v15, v15, v24, v212 bitop3:0xf6
    s_waitcnt vmcnt(3)
    v_bitop3_b32 v15, v15, v28, v212 bitop3:0xf6
    s_waitcnt vmcnt(2)
    v_bitop3_b32 v15, v15, v32, v212 bitop3:0xf6
    s_waitcnt vmcnt(1)
    v_bitop3_b32 v15, v15, v36, v212 bitop3:0xf6
    s_waitcnt vmcnt(0)
    v_bitop3_b32 v15, v15, v40, v212 bitop3:0xf6
    v_and_b32 v15, 0xff, v15
    v_cmp_ne_u32 vcc, 0, v15
    s_sub_u32 s50, s50, 1
    s_cbranch_scc1 LF_osum
    s_cbranch_vccnz LF_ob
LF_osum:
    v_xor_b32 v16, v16, v213
    v_xor_b32 v17, v17, v214
    v_xor_b32 v20, v20, v213
    v_xor_b32 v21, v21, v214
    v_pk_add_f32 v[54:55], v[18:19], v[22:23]
    v_pk_add_f32 v[52:53], v[16:17], v[20:21]
    v_xor_b32 v24, v24, v213
    v_xor_b32 v25, v25, v214
    v_pk_add_f32 v[54:55], v[54:55], v[26:27]
    v_pk_add_f32 v[52:53], v[52:53], v[24:25]
    v_xor_b32 v28, v28, v213
    v_xor_b32 v29, v29, v214
    v_pk_add_f32 v[54:55], v[54:55], v[30:31]
    v_pk_add_f32 v[52:53], v[52:53], v[28:29]
    v_xor_b32 v32, v32, v213
    v_xor_b32 v33, v33, v214
    v_pk_add_f32 v[54:55], v[54:55], v[34:35]
    v_pk_add_f32 v[52:53], v[52:53], v[32:33]
    v_xor_b32 v36, v36, v213
    v_xor_b32 v37, v37, v214
    v_pk_add_f32 v[54:55], v[54:55], v[38:39]
    v_pk_add_f32 v[52:53], v[52:53], v[36:37]
    v_xor_b32 v40, v40, v213
    v_xor_b32 v41, v41, v214
    v_pk_add_f32 v[54:55], v[54:55], v[42:43]
    v_pk_add_f32 v[52:53], v[52:53], v[40:41]
    v_or_b32 v15, v16, v17
    v_or3_b32 v15, v15, v20, v21
    v_add_f32_dpp v56, v54, v54 row_ror:8 row_mask:0xf bank_mask:0x3
    v_add_f32_dpp v57, v52, v52 row_ror:8 row_mask:0xf bank_mask:0x3
    v_or3_b32 v15, v15, v24, v25
    v_add_f32_dpp v56, v55, v55 row_ror:8 row_mask:0xf bank_mask:0xc
    v_add_f32_dpp v57, v53, v53 row_ror:8 row_mask:0xf bank_mask:0xc
    v_or3_b32 v15, v15, v28, v29
    v_or3_b32 v15, v15, v32, v33
    v_permlane16_swap_b32 v57, v56
    v_add_f32 v52, v57, v56
    v_mov_b32 v56, v52
    v_or3_b32 v15, v15, v36, v37
    v_or3_b32 v15, v15, v40, v41
    v_permlane32_swap_b32 v52, v56
    v_add_f32 v52, v52, v56
    v_and_b32 v15, 0xff, v15
    v_cmp_ne_u32 vcc, 0, v15
    v_cvt_pk_bf16_f32 v52, v52, v52
    v_lshlrev_b32 v52, 16, v52
    s_cbranch_vccnz LF_obad
LF_obad_ok:
    v_lshlrev_b32 v10, 16, v6
    v_lshlrev_b32 v5, 16, v5
    v_add_f32 v6, v10, v52
    v_cvt_pk_bf16_f32 v6, v6, v6
    v_lshlrev_b32 v6, 16, v6
    v_mul_f32 v9, 0xbfb8aa3b, v6
    v_exp_f32 v9, v9
    s_nop 0
    v_add_f32 v9, 1.0, v9
    v_rcp_f32 v9, v9
    s_nop 0
    v_mul_f32 v6, v6, v9
    v_cvt_pk_bf16_f32 v6, v6, v6
    v_lshlrev_b32 v6, 16, v6
LF_skipo:
    s_cmp_eq_u32 s49, 1
    s_cbranch_scc1 LF_esum
    s_waitcnt vmcnt(0)
    v_cmp_ne_u32 vcc, s34, v13
    s_cbranch_vccz LF_eiss
    s_mov_b32 s45, 200000
LF_poll:
    buffer_load_dword v13, v8, s[4:7], s46 offen sc1
    s_sub_u32 s45, s45, 1
    s_cbranch_scc1 LF_poll_d
    s_waitcnt vmcnt(0)
    v_cmp_ne_u32 vcc, s34, v13
    s_cbranch_vccnz LF_poll
LF_poll_d:
LF_eiss:
    s_mov_b32 s45, s42
    buffer_load_dwordx4 v[64:67], v7, s[4:7], s45 offen sc1
    s_add_u32 s45, s45, 20480
    buffer_load_dwordx4 v[68:71], v7, s[4:7], s45 offen sc1
    s_add_u32 s45, s45, 20480
    buffer_load_dwordx4 v[72:75], v7, s[4:7], s45 offen sc1
    s_add_u32 s45, s45, 20480
    buffer_load_dwordx4 v[76:79], v7, s[4:7], s45 offen sc1
    s_add_u32 s45, s45, 20480
    buffer_load_dwordx4 v[80:83], v7, s[4:7], s45 offen sc1
    s_add_u32 s45, s45, 20480
    buffer_load_dwordx4 v[84:87], v7, s[4:7], s45 offen sc1
    s_add_u32 s45, s45, 20480
    buffer_load_dwordx4 v[88:91], v7, s[4:7], s45 offen sc1
    s_add_u32 s45, s45, 20480
    buffer_load_dwordx4 v[92:95], v7, s[4:7], s45 offen sc1
LF_esum:
    s_waitcnt vmcnt(7)
    v_xor_b32 v64, v64, v213
    v_xor_b32 v65, v65, v214
    s_waitcnt vmcnt(6)
    v_xor_b32 v68, v68, v213
    v_xor_b32 v69, v69, v214
    v_pk_add_f32 v[54:55], v[66:67], v[70:71]
    v_pk_add_f32 v[52:53], v[64:65], v[68:69]
    s_waitcnt vmcnt(5)
    v_xor_b32 v72, v72, v213
    v_xor_b32 v73, v73, v214
    v_pk_add_f32 v[54:55], v[54:55], v[74:75]
    v_pk_add_f32 v[52:53], v[52:53], v[72:73]
    s_waitcnt vmcnt(4)
    v_xor_b32 v76, v76, v213
    v_xor_b32 v77, v77, v214
    v_pk_add_f32 v[54:55], v[54:55], v[78:79]
    v_pk_add_f32 v[52:53], v[52:53], v[76:77]
    s_waitcnt vmcnt(3)
    v_xor_b32 v80, v80, v213
    v_xor_b32 v81, v81, v214
    v_pk_add_f32 v[54:55], v[54:55], v[82:83]
    v_pk_add_f32 v[52:53], v[52:53], v[80:81]
    s_waitcnt vmcnt(2)
    v_xor_b32 v84, v84, v213
    v_xor_b32 v85, v85, v214
    v_pk_add_f32 v[54:55], v[54:55], v[86:87]
    v_pk_add_f32 v[52:53], v[52:53], v[84:85]
    s_waitcnt vmcnt(1)
    v_xor_b32 v88, v88, v213
    v_xor_b32 v89, v89, v214
    v_pk_add_f32 v[54:55], v[54:55], v[90:91]
    v_pk_add_f32 v[52:53], v[52:53], v[88:89]
    s_waitcnt vmcnt(0)
    v_xor_b32 v92, v92, v213
    v_xor_b32 v93, v93, v214
    v_pk_add_f32 v[54:55], v[54:55], v[94:95]
    v_pk_add_f32 v[52:53], v[52:53], v[92:93]
    v_or_b32 v15, v64, v65
    v_or3_b32 v15, v15, v68, v69
    v_add_f32_dpp v56, v54, v54 row_ror:8 row_mask:0xf bank_mask:0x3
    v_add_f32_dpp v57, v52, v52 row_ror:8 row_mask:0xf bank_mask:0x3
    v_or3_b32 v15, v15, v72, v73
    v_add_f32_dpp v56, v55, v55 row_ror:8 row_mask:0xf bank_mask:0xc
    v_add_f32_dpp v57, v53, v53 row_ror:8 row_mask:0xf bank_mask:0xc
    v_or3_b32 v15, v15, v76, v77
    v_or3_b32 v15, v15, v80, v81
    v_permlane16_swap_b32 v57, v56
    v_add_f32 v52, v57, v56
    v_mov_b32 v56, v52
    v_or3_b32 v15, v15, v84, v85
    v_or3_b32 v15, v15, v88, v89
    v_permlane32_swap_b32 v52, v56
    v_add_f32 v52, v52, v56
    v_or3_b32 v15, v15, v92, v93
    v_and_b32 v15, 0xff, v15
    v_cmp_ne_u32 vcc, 0, v15
    v_cvt_pk_bf16_f32 v52, v52, v52
    v_lshlrev_b32 v52, 16, v52
    v_mul_f32 v52, v52, v6
    v_cvt_pk_bf16_f32 v52, v52, v52
    v_lshlrev_b32 v52, 16, v52
    v_add_f32 v52, v52, v5
    v_cvt_pk_bf16_f32 v52, v52, v52
    s_cbranch_vccnz LF_ebad
LF_ebad_ok:
    s_mov_b32 exec_hi, 0
    buffer_store_short v52, v4, s[28:31], s41 offen nt
    s_cmp_eq_u32 s40, 0
    s_cbranch_scc0 LF_noep
    buffer_store_dword v212, v216, s[4:7], 0 offen nt
LF_noep:
    s_mov_b64 exec, -1
L_fin:
L_end:
    s_endpgm
LF_obad:
    s_sub_u32 s51, s51, 1
    s_cbranch_scc1 LF_obad_ok
    s_mov_b32 s45, s43
    buffer_load_dwordx4 v[16:19], v7, s[4:7], s45 offen sc1
    s_add_u32 s45, s45, 20480
    buffer_load_dwordx4 v[20:23], v7, s[4:7], s45 offen sc1
    s_add_u32 s45, s45, 20480
    buffer_load_dwordx4 v[24:27], v7, s[4:7], s45 offen sc1
    s_add_u32 s45, s45, 20480
    buffer_load_dwordx4 v[28:31], v7, s[4:7], s45 offen sc1
    s_add_u32 s45, s45, 20480
    buffer_load_dwordx4 v[32:35], v7, s[4:7], s45 offen sc1
    s_add_u32 s45, s45, 20480
    buffer_load_dwordx4 v[36:39], v7, s[4:7], s45 offen sc1
    s_add_u32 s45, s45, 20480
    v_mov_b32 v40, v213
    v_mov_b32 v41, v214
    v_mov_b32 v42, 0
    v_mov_b32 v43, 0
    s_mov_b32 exec_hi, 65535
    buffer_load_dwordx4 v[40:43], v7, s[4:7], s45 offen sc1
    s_mov_b64 exec, -1
    s_waitcnt vmcnt(0)
    s_branch LF_osum
LF_ebad:
    s_sub_u32 s51, s51, 1
    s_cbranch_scc1 LF_ebad_ok
    s_branch LF_eiss
LP_bad:
    s_sub_u32 s51, s51, 1
    s_cbranch_scc1 LP_ok
    s_mov_b32 m0, s44
    s_nop 7
    s_branch LP_retry
LY_bad:
    s_sub_u32 s51, s51, 1
    s_cbranch_scc1 LY_ok
    s_nop 7
    s_barrier
    s_mov_b32 m0, s50
    s_nop 0
    buffer_load_dwordx4 v24, s[4:7], s49 offen sc1 lds
    s_add_u32 m0, m0, 1024
    s_nop 0
    buffer_load_dwordx4 v25, s[4:7], s49 offen sc1 lds
    s_add_u32 m0, m0, 1024
    s_nop 0
    buffer_load_dwordx4 v26, s[4:7], s49 offen sc1 lds
    s_add_u32 m0, m0, 1024
    s_nop 0
    buffer_load_dwordx4 v27, s[4:7], s49 offen sc1 lds
    s_add_u32 m0, m0, 1024
    s_nop 0
    buffer_load_dwordx4 v28, s[4:7], s49 offen sc1 lds
    s_add_u32 m0, m0, 1024
    s_nop 0
    buffer_load_dwordx4 v29, s[4:7], s49 offen sc1 lds
    s_waitcnt vmcnt(0)
    s_branch LY_retry
L_codeend:
.section .rodata,"a"
.p2align 6
.amdhsa_kernel recurrent_scan__compressed_kv_cla__dense_activation_squared_relu__decode_kernel
  .amdhsa_next_free_vgpr 512
  .amdhsa_next_free_sgpr 102
  .amdhsa_accum_offset 256
  .amdhsa_group_segment_fixed_size 0
  .amdhsa_kernarg_size 112
  .amdhsa_user_sgpr_count 2
  .amdhsa_user_sgpr_kernarg_segment_ptr 1
  .amdhsa_system_sgpr_workgroup_id_x 1
.end_amdhsa_kernel
```
